```python
import torch

def _softmax(x, axis=-1):
    return torch.softmax(x, dim=axis)
def _gelu(x):
    return torch.nn.functional.gelu(x, approximate="tanh")
def _silu(x):
    return torch.nn.functional.silu(x)
def _sigmoid(x):
    return torch.sigmoid(x)
def _layernorm(x, axis=-1, eps=1e-5):
    m = x.mean(dim=axis, keepdim=True)
    v = x.var(dim=axis, keepdim=True, unbiased=False)
    return (x - m) / torch.sqrt(v + eps)
def _scatter_add(tgt, idx, src, axis=0):
    return tgt.clone().index_add_(axis, idx, src)
def _segment_sum(src, seg, n):
    out = torch.zeros((n,) + src.shape[1:], dtype=src.dtype)
    return out.index_add_(0, seg, src)
def _pad(x, pw):
    flat = tuple(v for pair in reversed(pw) for v in pair)
    return torch.nn.functional.pad(x, flat)

kernel_name = 'concat_heads__grouped_kv_mqa__mha_block__prompt'

def setup_inputs():

    _w = (lambda a: (lambda t: t.to(torch.bfloat16) if t.is_floating_point() else t)(torch.as_tensor(a)))
    def _A_setup():
        B, S, D, H = 1, 2048, 640, 32
        Dh = D // H
        return {
            "x": _w((lambda *s: torch.randn(*s, dtype=torch.bfloat16) * 0.05)(B, S, D)),
            "wq": _w((lambda *s: torch.randn(*s, dtype=torch.bfloat16) * 0.8)(D, H * Dh)),
            "wk": _w((lambda *s: torch.randn(*s, dtype=torch.bfloat16) * 0.8)(D, Dh)),
            "wv": _w((lambda *s: torch.randn(*s, dtype=torch.bfloat16) * 0.1)(D, Dh)),
            "wo": _w((lambda *s: torch.randn(*s, dtype=torch.bfloat16) * 0.1)(H * Dh, D)),
        }
    _A_in = _A_setup()

    def _B_setup():
        B, S, D, H = 1, 2048, 640, 32
        return {
            "x": _w((lambda *s: torch.randn(*s, dtype=torch.bfloat16) * 0.2)(B, S, D)),
            "wqkv": _w((lambda *s: torch.randn(*s, dtype=torch.bfloat16) * 0.2)(D, 3 * D)),
            "wo": _w((lambda *s: torch.randn(*s, dtype=torch.bfloat16) * 0.05)(D, D)),
        }
    _B_in = _B_setup()

    return {
        "A_x": _A_in["x"],
        "A_wq": _A_in["wq"],
        "A_wk": _A_in["wk"],
        "A_wv": _A_in["wv"],
        "A_wo": _A_in["wo"],
        "B_x": _B_in["x"],
        "B_wqkv": _B_in["wqkv"],
        "B_wo": _B_in["wo"],
    }

def reference(A_x, A_wq, A_wk, A_wv, A_wo, B_x, B_wqkv, B_wo):
    def _A_ref(x, wq, wk, wv, wo):
        B, S, D = x.shape
        H = 32
        Dh = D // H
        q = (lambda x, *d: x.permute(*d))((x @ wq).reshape(B, S, H, Dh), 0, 2, 1, 3)
        k = x @ wk
        v = x @ wv
        scores = torch.einsum("bhqd,bkd->bhqk", q, k) * (Dh ** -0.5)
        p = _softmax(scores, axis=-1)
        o = torch.einsum("bhqk,bkd->bhqd", p, v)
        return (lambda x, *d: x.permute(*d))(o, 0, 2, 1, 3).reshape(B, S, H * Dh) @ wo

    def _B_ref(x, wqkv, wo):
        B, S, D = x.shape
        H = 32
        Dh = D // H
        qkv = (lambda x, *d: x.permute(*d))((x @ wqkv).reshape(B, S, 3, H, Dh), 2, 0, 3, 1, 4)
        q, k, v = qkv[0], qkv[1], qkv[2]
        scores = torch.einsum("bhqd,bhkd->bhqk", q, k) * (Dh ** -0.5)
        p = _softmax(scores, axis=-1)
        o = torch.einsum("bhqk,bhkd->bhqd", p, v)
        return (lambda x, *d: x.permute(*d))(o, 0, 2, 1, 3).reshape(B, S, D) @ wo

    a = _A_ref(A_x, A_wq, A_wk, A_wv, A_wo)
    b = _B_ref(B_x, B_wqkv, B_wo)
    return torch.concatenate([a, b], axis=-1)
```

```asm
; @launch kernel=proj_kernel grid=(256,1,1) block=(512,1,1) lds=126016
; @launch kernel=attn_kernel grid=(256,1,1) block=(512,1,1) lds=163840
.amdgcn_target "amdgcn-amd-amdhsa--gfx950"
.text
.globl proj_kernel
.p2align 8
.type proj_kernel,@function
proj_kernel:
  s_cmp_ge_u32 s2, 256
  s_cbranch_scc1 L_k1_done

  s_load_dwordx16 s[36:51], s[0:1], 0
  s_load_dwordx2 s[52:53], s[0:1], 80
  v_lshrrev_b32 v2, 6, v0
  v_and_b32 v1, 63, v0
  v_readfirstlane_b32 s25, v2
  s_nop 2
  s_cmp_eq_u32 s25, 0
  s_cbranch_scc0 L_k1_nocpf
  s_getpc_b64 s[30:31]
L_pc_1:
  s_sub_u32 s30, s30, L_pc_1-proj_kernel
  s_subb_u32 s31, s31, 0
  v_lshlrev_b32 v3, 7, v1
  v_min_u32 v3, L_k1_done-proj_kernel-4, v3
  global_load_dword v63, v3, s[30:31]
  v_lshlrev_b32 v3, 7, v1
  v_add_u32 v3, 8192, v3
  v_min_u32 v3, L_k1_done-proj_kernel-4, v3
  global_load_dword v63, v3, s[30:31]
L_k1_nocpf:

  s_add_u32 s26, s2, 6
  s_and_b32 s26, s26, 7
  s_lshr_b32 s27, s2, 3
  s_cmp_ge_u32 s26, 6
  s_cselect_b32 s20, 1, 0
  s_cmp_ge_u32 s26, 3
  s_cselect_b32 s28, 1, 0
  s_mul_i32 s29, s28, 3
  s_sub_u32 s29, s26, s29
  s_sub_u32 s30, s26, 6
  s_cmp_eq_u32 s20, 1
  s_cselect_b32 s28, s30, s28
  s_cselect_b32 s29, 0, s29
  s_lshl_b32 s30, s28, 3
  s_and_b32 s31, s27, 7
  s_add_u32 s21, s30, s31
  s_lshl_b32 s30, s29, 2
  s_lshr_b32 s31, s27, 3
  s_add_u32 s22, s30, s31
  s_mov_b32 s54, s27
  s_mov_b32 s55, s28
  s_mov_b32 s68, s29
  s_lshr_b32 s23, s22, 2
  s_and_b32 s24, s22, 3
  s_cmp_eq_u32 s20, 1
  s_cselect_b32 s23, 0, s23
  s_waitcnt lgkmcnt(0)
  s_cmp_ge_u32 s25, 4
  s_cbranch_scc0 L_k1_consumer
  s_cmp_eq_u32 s20, 1
  s_cselect_b32 s26, s36, s46
  s_cselect_b32 s27, s37, s47
  s_mul_i32 s28, s21, 163840
  s_add_u32 s8, s26, s28
  s_addc_u32 s9, s27, 0
  s_and_b32 s9, s9, 0xffff
  s_mov_b32 s10, 163840
  s_mov_b32 s11, 0x20000
  s_cmp_eq_u32 s20, 1
  s_cselect_b32 s26, s38, s48
  s_cselect_b32 s27, s39, s49
  s_mov_b32 s29, 2457600
  s_cselect_b32 s29, 819200, s29
  s_mul_i32 s28, s22, 320
  s_add_u32 s12, s26, s28
  s_addc_u32 s13, s27, 0
  s_and_b32 s13, s13, 0xffff
  s_sub_u32 s14, s29, s28
  s_mov_b32 s15, 0x20000
  s_cmp_eq_u32 s20, 1
  s_cbranch_scc1 L_k1_loader_A
  s_sub_u32 s26, s25, 4
  v_lshrrev_b32 v10, 3, v1
  s_lshl_b32 s27, s26, 3
  v_add_u32 v10, s27, v10
  v_lshrrev_b32 v11, 1, v10
  v_and_b32 v11, 7, v11
  v_and_b32 v12, 7, v1
  v_xor_b32 v12, v12, v11
  v_lshlrev_b32 v12, 4, v12
  v_mul_u32_u24 v10, 1280, v10
  v_add_u32 v2, v10, v12
  v_add_u32 v14, 40960, v2
  v_add_u32 v15, 81920, v2
  v_add_u32 v16, 122880, v2
  s_lshl_b32 s32, s26, 10
  s_mov_b32 s29, 0
  s_add_u32 m0, s32, 0
  s_nop 0
  buffer_load_dwordx4 v2, s[8:11], s29 offen lds
  s_add_u32 m0, s32, 4096
  s_nop 0
  buffer_load_dwordx4 v14, s[8:11], s29 offen lds
  s_add_u32 m0, s32, 8192
  s_nop 0
  buffer_load_dwordx4 v15, s[8:11], s29 offen lds
  s_add_u32 m0, s32, 12288
  s_nop 0
  buffer_load_dwordx4 v16, s[8:11], s29 offen lds
  s_movk_i32 s28, 3277
  s_movk_i32 s30, 3840
  s_lshl_b32 s27, s26, 6
  v_add_u32 v10, s27, v1
  v_mul_lo_u32 v11, v10, s28
  v_lshrrev_b32 v11, 16, v11
  v_mul_u32_u24 v12, 20, v11
  v_sub_u32 v12, v10, v12
  v_lshrrev_b32 v13, 2, v11
  v_and_b32 v13, 2, v13
  v_xor_b32 v13, v12, v13
  v_mul_lo_u32 v9, v11, s30
  v_lshl_add_u32 v3, v13, 4, v9
  s_add_u32 m0, s32, 16384
  s_nop 0
  buffer_load_dwordx4 v3, s[12:15], s29 offen lds
  v_add_u32 v12, 16, v12
  v_cmp_le_u32 vcc, 20, v12
  v_add_u32 v11, 12, v11
  v_subrev_u32 v13, 20, v12
  v_addc_co_u32 v11, vcc, 0, v11, vcc
  v_min_u32 v12, v12, v13
  v_lshrrev_b32 v13, 2, v11
  v_and_b32 v13, 2, v13
  v_xor_b32 v13, v12, v13
  v_mul_lo_u32 v9, v11, s30
  v_lshl_add_u32 v4, v13, 4, v9
  s_add_u32 m0, s32, 20480
  s_nop 0
  buffer_load_dwordx4 v4, s[12:15], s29 offen lds
  v_add_u32 v12, 16, v12
  v_cmp_le_u32 vcc, 20, v12
  v_add_u32 v11, 12, v11
  v_subrev_u32 v13, 20, v12
  v_addc_co_u32 v11, vcc, 0, v11, vcc
  v_min_u32 v12, v12, v13
  v_lshrrev_b32 v13, 2, v11
  v_and_b32 v13, 2, v13
  v_xor_b32 v13, v12, v13
  v_mul_lo_u32 v9, v11, s30
  v_lshl_add_u32 v5, v13, 4, v9
  s_add_u32 m0, s32, 24576
  s_nop 0
  buffer_load_dwordx4 v5, s[12:15], s29 offen lds
  v_add_u32 v12, 16, v12
  v_cmp_le_u32 vcc, 20, v12
  v_add_u32 v11, 12, v11
  v_subrev_u32 v13, 20, v12
  v_addc_co_u32 v11, vcc, 0, v11, vcc
  v_min_u32 v12, v12, v13
  v_lshrrev_b32 v13, 2, v11
  v_and_b32 v13, 2, v13
  v_xor_b32 v13, v12, v13
  v_mul_lo_u32 v9, v11, s30
  v_lshl_add_u32 v6, v13, 4, v9
  s_add_u32 m0, s32, 28672
  s_nop 0
  buffer_load_dwordx4 v6, s[12:15], s29 offen lds
  v_add_u32 v12, 16, v12
  v_cmp_le_u32 vcc, 20, v12
  v_add_u32 v11, 12, v11
  v_subrev_u32 v13, 20, v12
  v_addc_co_u32 v11, vcc, 0, v11, vcc
  v_min_u32 v12, v12, v13
  v_lshrrev_b32 v13, 2, v11
  v_and_b32 v13, 2, v13
  v_xor_b32 v13, v12, v13
  v_mul_lo_u32 v9, v11, s30
  v_lshl_add_u32 v7, v13, 4, v9
  s_add_u32 m0, s32, 32768
  s_nop 0
  buffer_load_dwordx4 v7, s[12:15], s29 offen lds
  s_mov_b32 s31, 0
  s_mov_b32 s29, 128
  s_mov_b32 s30, 245760
  s_add_u32 m0, s32, 36864
  s_nop 0
  buffer_load_dwordx4 v2, s[8:11], s29 offen lds
  s_add_u32 m0, s32, 40960
  s_nop 0
  buffer_load_dwordx4 v14, s[8:11], s29 offen lds
  s_add_u32 m0, s32, 45056
  s_nop 0
  buffer_load_dwordx4 v15, s[8:11], s29 offen lds
  s_add_u32 m0, s32, 49152
  s_nop 0
  buffer_load_dwordx4 v16, s[8:11], s29 offen lds
  s_add_u32 m0, s32, 53248
  s_add_u32 s29, s29, 128
  buffer_load_dwordx4 v3, s[12:15], s30 offen lds
  s_add_u32 m0, s32, 57344
  s_nop 0
  buffer_load_dwordx4 v4, s[12:15], s30 offen lds
  s_add_u32 m0, s32, 61440
  s_nop 0
  buffer_load_dwordx4 v5, s[12:15], s30 offen lds
  s_add_u32 m0, s32, 65536
  s_nop 0
  buffer_load_dwordx4 v6, s[12:15], s30 offen lds
  s_add_u32 m0, s32, 69632
  s_nop 0
  buffer_load_dwordx4 v7, s[12:15], s30 offen lds
  s_add_u32 s30, s30, 245760
  s_add_u32 m0, s32, 73728
  s_nop 0
  buffer_load_dwordx4 v2, s[8:11], s29 offen lds
  s_add_u32 m0, s32, 77824
  s_nop 0
  buffer_load_dwordx4 v14, s[8:11], s29 offen lds
  s_add_u32 m0, s32, 81920
  s_nop 0
  buffer_load_dwordx4 v15, s[8:11], s29 offen lds
  s_add_u32 m0, s32, 86016
  s_nop 0
  buffer_load_dwordx4 v16, s[8:11], s29 offen lds
  s_add_u32 m0, s32, 90112
  s_add_u32 s29, s29, 128
  buffer_load_dwordx4 v3, s[12:15], s30 offen lds
  s_add_u32 m0, s32, 94208
  s_nop 0
  buffer_load_dwordx4 v4, s[12:15], s30 offen lds
  s_add_u32 m0, s32, 98304
  s_nop 0
  buffer_load_dwordx4 v5, s[12:15], s30 offen lds
  s_add_u32 m0, s32, 102400
  s_nop 0
  buffer_load_dwordx4 v6, s[12:15], s30 offen lds
  s_add_u32 m0, s32, 106496
  s_nop 0
  buffer_load_dwordx4 v7, s[12:15], s30 offen lds
  s_add_u32 s30, s30, 245760
  s_cmp_eq_u32 s20, 1
  s_cselect_b32 s36, s36, s46
  s_cselect_b32 s37, s37, s47
  s_lshl_b32 s38, s55, 10
  s_lshl_b32 s39, s54, 5
  s_add_u32 s38, s38, s39
  s_lshl_b32 s39, s26, 3
  s_add_u32 s38, s38, s39
  s_mul_i32 s38, s38, 1280
  s_add_u32 s60, s36, s38
  s_addc_u32 s61, s37, 0
  s_and_b32 s61, s61, 0xffff
  s_mov_b32 s62, 10240
  s_mov_b32 s63, 0x20000
  v_and_b32 v10, 7, v1
  v_mul_u32_u24 v10, 1280, v10
  v_lshrrev_b32 v11, 3, v1
  v_lshl_add_u32 v17, v11, 7, v10
  s_mul_i32 s38, s68, 1280
  s_mul_i32 s39, s22, 320
  s_sub_u32 s38, s39, s38
  s_sub_u32 s48, s12, s38
  s_subb_u32 s49, s13, 0
  s_and_b32 s49, s49, 0xffff
  s_add_u32 s50, s14, s38
  s_mov_b32 s51, 0x20000
  s_movk_i32 s38, 13108
  v_mul_lo_u32 v11, v1, s38
  v_lshrrev_b32 v11, 16, v11
  v_mul_u32_u24 v12, 5, v11
  v_sub_u32 v12, v1, v12
  s_mul_i32 s38, s54, 20
  s_mul_i32 s39, s26, 5
  s_add_u32 s38, s38, s39
  v_add_u32 v12, s38, v12
  s_movk_i32 s38, 6554
  v_mul_lo_u32 v13, v12, s38
  v_lshrrev_b32 v13, 16, v13
  v_mul_u32_u24 v9, 10, v13
  v_sub_u32 v9, v12, v9
  v_lshl_add_u32 v13, v11, 6, v13
  s_movk_i32 s38, 3840
  v_mul_lo_u32 v13, v13, s38
  v_lshl_add_u32 v18, v9, 7, v13
  s_mov_b32 exec_lo, 0xffff
  s_mov_b32 exec_hi, 0x0
  s_mov_b32 s38, 384
  buffer_load_dword v63, v17, s[60:63], s38 offen
  s_mov_b32 exec_lo, 0x3ff
  s_mov_b32 exec_hi, 0x0
  s_mov_b32 s38, 737280
  buffer_load_dword v62, v18, s[48:51], s38 offen
  s_mov_b64 exec, -1
  s_waitcnt vmcnt(20)
  s_barrier
  s_mov_b32 exec_lo, 0xffff
  s_mov_b32 exec_hi, 0x0
  s_mov_b32 s38, 640
  buffer_load_dword v63, v17, s[60:63], s38 offen
  s_mov_b32 exec_lo, 0x3ff
  s_mov_b32 exec_hi, 0x0
  s_mov_b32 s38, 1228800
  buffer_load_dword v62, v18, s[48:51], s38 offen
  s_mov_b64 exec, -1
  s_waitcnt vmcnt(13)
  s_barrier
  s_mov_b32 exec_lo, 0xffffff
  s_mov_b32 exec_hi, 0x0
  s_mov_b32 s38, 896
  buffer_load_dword v63, v17, s[60:63], s38 offen
  s_mov_b32 exec_lo, 0x7fff
  s_mov_b32 exec_hi, 0x0
  s_mov_b32 s38, 1720320
  buffer_load_dword v62, v18, s[48:51], s38 offen
  s_mov_b64 exec, -1
  s_add_u32 m0, s32, 0
  s_nop 0
  buffer_load_dwordx4 v2, s[8:11], s29 offen lds
  s_add_u32 m0, s32, 4096
  s_nop 0
  buffer_load_dwordx4 v14, s[8:11], s29 offen lds
  s_add_u32 m0, s32, 8192
  s_nop 0
  buffer_load_dwordx4 v15, s[8:11], s29 offen lds
  s_add_u32 m0, s32, 12288
  s_nop 0
  buffer_load_dwordx4 v16, s[8:11], s29 offen lds
  s_add_u32 m0, s32, 16384
  s_add_u32 s29, s29, 128
  buffer_load_dwordx4 v3, s[12:15], s30 offen lds
  s_add_u32 m0, s32, 20480
  s_nop 0
  buffer_load_dwordx4 v4, s[12:15], s30 offen lds
  s_add_u32 m0, s32, 24576
  s_nop 0
  buffer_load_dwordx4 v5, s[12:15], s30 offen lds
  s_add_u32 m0, s32, 28672
  s_nop 0
  buffer_load_dwordx4 v6, s[12:15], s30 offen lds
  s_add_u32 m0, s32, 32768
  s_nop 0
  buffer_load_dwordx4 v7, s[12:15], s30 offen lds
  s_add_u32 s30, s30, 245760
  s_waitcnt vmcnt(15)
  s_barrier
  s_add_u32 m0, s32, 36864
  s_nop 0
  buffer_load_dwordx4 v2, s[8:11], s29 offen lds
  s_add_u32 m0, s32, 40960
  s_nop 0
  buffer_load_dwordx4 v14, s[8:11], s29 offen lds
  s_add_u32 m0, s32, 45056
  s_nop 0
  buffer_load_dwordx4 v15, s[8:11], s29 offen lds
  s_add_u32 m0, s32, 49152
  s_nop 0
  buffer_load_dwordx4 v16, s[8:11], s29 offen lds
  s_add_u32 m0, s32, 53248
  s_add_u32 s29, s29, 128
  buffer_load_dwordx4 v3, s[12:15], s30 offen lds
  s_add_u32 m0, s32, 57344
  s_nop 0
  buffer_load_dwordx4 v4, s[12:15], s30 offen lds
  s_add_u32 m0, s32, 61440
  s_nop 0
  buffer_load_dwordx4 v5, s[12:15], s30 offen lds
  s_add_u32 m0, s32, 65536
  s_nop 0
  buffer_load_dwordx4 v6, s[12:15], s30 offen lds
  s_add_u32 m0, s32, 69632
  s_nop 0
  buffer_load_dwordx4 v7, s[12:15], s30 offen lds
  s_add_u32 s30, s30, 245760
  s_waitcnt vmcnt(9)
  s_barrier
  s_add_u32 m0, s32, 73728
  s_nop 0
  buffer_load_dwordx4 v2, s[8:11], s29 offen lds
  s_add_u32 m0, s32, 77824
  s_nop 0
  buffer_load_dwordx4 v14, s[8:11], s29 offen lds
  s_add_u32 m0, s32, 81920
  s_nop 0
  buffer_load_dwordx4 v15, s[8:11], s29 offen lds
  s_add_u32 m0, s32, 86016
  s_nop 0
  buffer_load_dwordx4 v16, s[8:11], s29 offen lds
  s_add_u32 m0, s32, 90112
  s_add_u32 s29, s29, 128
  buffer_load_dwordx4 v3, s[12:15], s30 offen lds
  s_add_u32 m0, s32, 94208
  s_nop 0
  buffer_load_dwordx4 v4, s[12:15], s30 offen lds
  s_add_u32 m0, s32, 98304
  s_nop 0
  buffer_load_dwordx4 v5, s[12:15], s30 offen lds
  s_add_u32 m0, s32, 102400
  s_nop 0
  buffer_load_dwordx4 v6, s[12:15], s30 offen lds
  s_add_u32 m0, s32, 106496
  s_nop 0
  buffer_load_dwordx4 v7, s[12:15], s30 offen lds
  s_add_u32 s30, s30, 245760
  s_waitcnt vmcnt(9)
  s_barrier
  s_add_u32 m0, s32, 0
  s_nop 0
  buffer_load_dwordx4 v2, s[8:11], s29 offen lds
  s_add_u32 m0, s32, 4096
  s_nop 0
  buffer_load_dwordx4 v14, s[8:11], s29 offen lds
  s_add_u32 m0, s32, 8192
  s_nop 0
  buffer_load_dwordx4 v15, s[8:11], s29 offen lds
  s_add_u32 m0, s32, 12288
  s_nop 0
  buffer_load_dwordx4 v16, s[8:11], s29 offen lds
  s_add_u32 m0, s32, 16384
  s_add_u32 s29, s29, 128
  buffer_load_dwordx4 v3, s[12:15], s30 offen lds
  s_add_u32 m0, s32, 20480
  s_nop 0
  buffer_load_dwordx4 v4, s[12:15], s30 offen lds
  s_add_u32 m0, s32, 24576
  s_nop 0
  buffer_load_dwordx4 v5, s[12:15], s30 offen lds
  s_add_u32 m0, s32, 28672
  s_nop 0
  buffer_load_dwordx4 v6, s[12:15], s30 offen lds
  s_add_u32 m0, s32, 32768
  s_nop 0
  buffer_load_dwordx4 v7, s[12:15], s30 offen lds
  s_add_u32 s30, s30, 245760
  s_waitcnt vmcnt(9)
  s_barrier
  s_add_u32 m0, s32, 36864
  s_nop 0
  buffer_load_dwordx4 v2, s[8:11], s29 offen lds
  s_add_u32 m0, s32, 40960
  s_nop 0
  buffer_load_dwordx4 v14, s[8:11], s29 offen lds
  s_add_u32 m0, s32, 45056
  s_nop 0
  buffer_load_dwordx4 v15, s[8:11], s29 offen lds
  s_add_u32 m0, s32, 49152
  s_nop 0
  buffer_load_dwordx4 v16, s[8:11], s29 offen lds
  s_add_u32 m0, s32, 53248
  s_add_u32 s29, s29, 128
  buffer_load_dwordx4 v3, s[12:15], s30 offen lds
  s_add_u32 m0, s32, 57344
  s_nop 0
  buffer_load_dwordx4 v4, s[12:15], s30 offen lds
  s_add_u32 m0, s32, 61440
  s_nop 0
  buffer_load_dwordx4 v5, s[12:15], s30 offen lds
  s_add_u32 m0, s32, 65536
  s_nop 0
  buffer_load_dwordx4 v6, s[12:15], s30 offen lds
  s_add_u32 m0, s32, 69632
  s_nop 0
  buffer_load_dwordx4 v7, s[12:15], s30 offen lds
  s_add_u32 s30, s30, 245760
  s_waitcnt vmcnt(9)
  s_barrier
  s_add_u32 m0, s32, 73728
  s_nop 0
  buffer_load_dwordx4 v2, s[8:11], s29 offen lds
  s_add_u32 m0, s32, 77824
  s_nop 0
  buffer_load_dwordx4 v14, s[8:11], s29 offen lds
  s_add_u32 m0, s32, 81920
  s_nop 0
  buffer_load_dwordx4 v15, s[8:11], s29 offen lds
  s_add_u32 m0, s32, 86016
  s_nop 0
  buffer_load_dwordx4 v16, s[8:11], s29 offen lds
  s_add_u32 m0, s32, 90112
  s_add_u32 s29, s29, 128
  buffer_load_dwordx4 v3, s[12:15], s30 offen lds
  s_add_u32 m0, s32, 94208
  s_nop 0
  buffer_load_dwordx4 v4, s[12:15], s30 offen lds
  s_add_u32 m0, s32, 98304
  s_nop 0
  buffer_load_dwordx4 v5, s[12:15], s30 offen lds
  s_add_u32 m0, s32, 102400
  s_nop 0
  buffer_load_dwordx4 v6, s[12:15], s30 offen lds
  s_add_u32 m0, s32, 106496
  s_nop 0
  buffer_load_dwordx4 v7, s[12:15], s30 offen lds
  s_add_u32 s30, s30, 245760
  s_waitcnt vmcnt(9)
  s_barrier
  s_add_u32 m0, s32, 0
  s_nop 0
  buffer_load_dwordx4 v2, s[8:11], s29 offen lds
  s_add_u32 m0, s32, 4096
  s_nop 0
  buffer_load_dwordx4 v14, s[8:11], s29 offen lds
  s_add_u32 m0, s32, 8192
  s_nop 0
  buffer_load_dwordx4 v15, s[8:11], s29 offen lds
  s_add_u32 m0, s32, 12288
  s_nop 0
  buffer_load_dwordx4 v16, s[8:11], s29 offen lds
  s_add_u32 m0, s32, 16384
  s_add_u32 s29, s29, 128
  buffer_load_dwordx4 v3, s[12:15], s30 offen lds
  s_add_u32 m0, s32, 20480
  s_nop 0
  buffer_load_dwordx4 v4, s[12:15], s30 offen lds
  s_add_u32 m0, s32, 24576
  s_nop 0
  buffer_load_dwordx4 v5, s[12:15], s30 offen lds
  s_add_u32 m0, s32, 28672
  s_nop 0
  buffer_load_dwordx4 v6, s[12:15], s30 offen lds
  s_add_u32 m0, s32, 32768
  s_nop 0
  buffer_load_dwordx4 v7, s[12:15], s30 offen lds
  s_add_u32 s30, s30, 245760
  s_waitcnt vmcnt(9)
  s_barrier
  s_waitcnt vmcnt(0)
  s_barrier
  s_lshl_b32 s27, s21, 2
  s_cmp_eq_u32 s23, 0
  s_cbranch_scc0 L_k1_cs_kv
  s_xor_b32 s28, s20, 1
  s_lshl_b32 s28, s28, 5
  s_lshl_b32 s29, s24, 3
  s_add_u32 s28, s28, s29
  s_mul_i32 s28, s28, 81920
  s_add_u32 s28, s28, 6291456
  s_mov_b32 s30, 81920
  s_mov_b32 s33, 1280
  s_mov_b32 s34, 0
  s_branch L_k1_cs_done
L_k1_cs_kv:
  s_lshl_b32 s29, s24, 3
  s_mul_i32 s28, s29, 163840
  s_add_u32 s28, s28, 0
  s_mov_b32 s30, 163840
  s_mov_b32 s33, 2560
  s_cmp_eq_u32 s23, 2
  s_cselect_b32 s34, 1280, 0
L_k1_cs_done:
  s_mul_i32 s27, s27, s33
  s_add_u32 s27, s27, s34
  s_add_u32 s28, s28, s27
  s_add_u32 s60, s52, s28
  s_addc_u32 s61, s53, 0
  s_and_b32 s61, s61, 0xffff
  s_lshl_b32 s29, s30, 3
  s_sub_u32 s62, s29, s27
  s_mov_b32 s63, 0x20000
  s_lshl_b32 s27, s25, 6
  v_add_u32 v11, s27, v1
  v_lshlrev_b32 v12, 4, v11
  v_add_u32 v41, 36864, v12
  s_movk_i32 s27, 3277
  v_add_u32 v12, 0, v11
  v_mul_lo_u32 v13, v12, s27
  v_lshrrev_b32 v13, 18, v13
  v_mul_u32_u24 v14, 80, v13
  v_sub_u32 v14, v12, v14
  v_lshrrev_b32 v15, 2, v13
  v_mul_lo_u32 v15, v15, s30
  v_and_b32 v13, 3, v13
  v_mul_lo_u32 v13, v13, s33
  v_lshl_add_u32 v14, v14, 4, v15
  v_add_u32 v36, v14, v13
  v_add_u32 v12, 512, v11
  v_mul_lo_u32 v13, v12, s27
  v_lshrrev_b32 v13, 18, v13
  v_mul_u32_u24 v14, 80, v13
  v_sub_u32 v14, v12, v14
  v_lshrrev_b32 v15, 2, v13
  v_mul_lo_u32 v15, v15, s30
  v_and_b32 v13, 3, v13
  v_mul_lo_u32 v13, v13, s33
  v_lshl_add_u32 v14, v14, 4, v15
  v_add_u32 v37, v14, v13
  v_add_u32 v12, 1024, v11
  v_mul_lo_u32 v13, v12, s27
  v_lshrrev_b32 v13, 18, v13
  v_mul_u32_u24 v14, 80, v13
  v_sub_u32 v14, v12, v14
  v_lshrrev_b32 v15, 2, v13
  v_mul_lo_u32 v15, v15, s30
  v_and_b32 v13, 3, v13
  v_mul_lo_u32 v13, v13, s33
  v_lshl_add_u32 v14, v14, 4, v15
  v_add_u32 v38, v14, v13
  v_add_u32 v12, 1536, v11
  v_mul_lo_u32 v13, v12, s27
  v_lshrrev_b32 v13, 18, v13
  v_mul_u32_u24 v14, 80, v13
  v_sub_u32 v14, v12, v14
  v_lshrrev_b32 v15, 2, v13
  v_mul_lo_u32 v15, v15, s30
  v_and_b32 v13, 3, v13
  v_mul_lo_u32 v13, v13, s33
  v_lshl_add_u32 v14, v14, 4, v15
  v_add_u32 v39, v14, v13
  v_add_u32 v12, 2048, v11
  v_mul_lo_u32 v13, v12, s27
  v_lshrrev_b32 v13, 18, v13
  v_mul_u32_u24 v14, 80, v13
  v_sub_u32 v14, v12, v14
  v_lshrrev_b32 v15, 2, v13
  v_mul_lo_u32 v15, v15, s30
  v_and_b32 v13, 3, v13
  v_mul_lo_u32 v13, v13, s33
  v_lshl_add_u32 v14, v14, 4, v15
  v_add_u32 v40, v14, v13
  s_add_u32 s56, s52, 5242880
  s_addc_u32 s57, s53, 0
  s_and_b32 s57, s57, 0xffff
  s_mov_b32 s58, 163840
  s_mov_b32 s59, 0x20000
  s_lshl_b32 s69, s21, 2
  s_add_u32 s69, s69, s22
  s_mul_i32 s69, s69, 2560
  v_lshlrev_b32 v42, 4, v11
  s_branch L_k1_copy
L_k1_loader_A:
  s_sub_u32 s26, s25, 4
  v_lshrrev_b32 v10, 3, v1
  s_lshl_b32 s27, s26, 3
  v_add_u32 v10, s27, v10
  v_lshrrev_b32 v11, 1, v10
  v_and_b32 v11, 7, v11
  v_and_b32 v12, 7, v1
  v_xor_b32 v12, v12, v11
  v_lshlrev_b32 v12, 4, v12
  v_mul_u32_u24 v10, 1280, v10
  v_add_u32 v2, v10, v12
  v_add_u32 v14, 40960, v2
  v_add_u32 v15, 81920, v2
  v_add_u32 v16, 122880, v2
  s_lshl_b32 s32, s26, 10
  s_mov_b32 s29, 0
  s_add_u32 m0, s32, 0
  s_nop 0
  buffer_load_dwordx4 v2, s[8:11], s29 offen lds
  s_add_u32 m0, s32, 4096
  s_nop 0
  buffer_load_dwordx4 v14, s[8:11], s29 offen lds
  s_add_u32 m0, s32, 8192
  s_nop 0
  buffer_load_dwordx4 v15, s[8:11], s29 offen lds
  s_add_u32 m0, s32, 12288
  s_nop 0
  buffer_load_dwordx4 v16, s[8:11], s29 offen lds
  s_movk_i32 s28, 3277
  s_movk_i32 s30, 1280
  s_lshl_b32 s27, s26, 6
  v_add_u32 v10, s27, v1
  v_mul_lo_u32 v11, v10, s28
  v_lshrrev_b32 v11, 16, v11
  v_mul_u32_u24 v12, 20, v11
  v_sub_u32 v12, v10, v12
  v_lshrrev_b32 v13, 2, v11
  v_and_b32 v13, 2, v13
  v_xor_b32 v13, v12, v13
  v_mul_lo_u32 v9, v11, s30
  v_lshl_add_u32 v3, v13, 4, v9
  s_add_u32 m0, s32, 16384
  s_nop 0
  buffer_load_dwordx4 v3, s[12:15], s29 offen lds
  v_add_u32 v12, 16, v12
  v_cmp_le_u32 vcc, 20, v12
  v_add_u32 v11, 12, v11
  v_subrev_u32 v13, 20, v12
  v_addc_co_u32 v11, vcc, 0, v11, vcc
  v_min_u32 v12, v12, v13
  v_lshrrev_b32 v13, 2, v11
  v_and_b32 v13, 2, v13
  v_xor_b32 v13, v12, v13
  v_mul_lo_u32 v9, v11, s30
  v_lshl_add_u32 v4, v13, 4, v9
  s_add_u32 m0, s32, 20480
  s_nop 0
  buffer_load_dwordx4 v4, s[12:15], s29 offen lds
  v_add_u32 v12, 16, v12
  v_cmp_le_u32 vcc, 20, v12
  v_add_u32 v11, 12, v11
  v_subrev_u32 v13, 20, v12
  v_addc_co_u32 v11, vcc, 0, v11, vcc
  v_min_u32 v12, v12, v13
  v_lshrrev_b32 v13, 2, v11
  v_and_b32 v13, 2, v13
  v_xor_b32 v13, v12, v13
  v_mul_lo_u32 v9, v11, s30
  v_lshl_add_u32 v5, v13, 4, v9
  s_add_u32 m0, s32, 24576
  s_nop 0
  buffer_load_dwordx4 v5, s[12:15], s29 offen lds
  v_add_u32 v12, 16, v12
  v_cmp_le_u32 vcc, 20, v12
  v_add_u32 v11, 12, v11
  v_subrev_u32 v13, 20, v12
  v_addc_co_u32 v11, vcc, 0, v11, vcc
  v_min_u32 v12, v12, v13
  v_lshrrev_b32 v13, 2, v11
  v_and_b32 v13, 2, v13
  v_xor_b32 v13, v12, v13
  v_mul_lo_u32 v9, v11, s30
  v_lshl_add_u32 v6, v13, 4, v9
  s_add_u32 m0, s32, 28672
  s_nop 0
  buffer_load_dwordx4 v6, s[12:15], s29 offen lds
  v_add_u32 v12, 16, v12
  v_cmp_le_u32 vcc, 20, v12
  v_add_u32 v11, 12, v11
  v_subrev_u32 v13, 20, v12
  v_addc_co_u32 v11, vcc, 0, v11, vcc
  v_min_u32 v12, v12, v13
  v_lshrrev_b32 v13, 2, v11
  v_and_b32 v13, 2, v13
  v_xor_b32 v13, v12, v13
  v_mul_lo_u32 v9, v11, s30
  v_lshl_add_u32 v7, v13, 4, v9
  s_add_u32 m0, s32, 32768
  s_nop 0
  buffer_load_dwordx4 v7, s[12:15], s29 offen lds
  s_mov_b32 s16, s40
  s_and_b32 s17, s41, 0xffff
  s_mov_b32 s18, 25600
  s_mov_b32 s19, 0x20000
  s_mov_b32 s56, s42
  s_and_b32 s57, s43, 0xffff
  s_mov_b32 s58, 25600
  s_mov_b32 s59, 0x20000
  s_mul_i32 s64, s26, 640
  v_lshlrev_b32 v10, 4, v1
  v_add_u32 v8, s64, v10
  s_mov_b32 s66, -1
  s_mov_b32 s67, 0xff
  s_mov_b32 s31, 0
  s_add_u32 m0, s64, 110592
  s_mov_b64 exec, s[66:67]
  buffer_load_dwordx4 v8, s[16:19], s31 offen lds
  s_add_u32 m0, s64, 113152
  s_nop 0
  buffer_load_dwordx4 v8, s[56:59], s31 offen lds
  s_mov_b64 exec, -1
  s_add_u32 s31, s31, 2560
  s_mov_b32 s29, 128
  s_mov_b32 s30, 81920
  s_add_u32 m0, s32, 36864
  s_nop 0
  buffer_load_dwordx4 v2, s[8:11], s29 offen lds
  s_add_u32 m0, s32, 40960
  s_nop 0
  buffer_load_dwordx4 v14, s[8:11], s29 offen lds
  s_add_u32 m0, s32, 45056
  s_nop 0
  buffer_load_dwordx4 v15, s[8:11], s29 offen lds
  s_add_u32 m0, s32, 49152
  s_nop 0
  buffer_load_dwordx4 v16, s[8:11], s29 offen lds
  s_add_u32 m0, s32, 53248
  s_add_u32 s29, s29, 128
  buffer_load_dwordx4 v3, s[12:15], s30 offen lds
  s_add_u32 m0, s32, 57344
  s_nop 0
  buffer_load_dwordx4 v4, s[12:15], s30 offen lds
  s_add_u32 m0, s32, 61440
  s_nop 0
  buffer_load_dwordx4 v5, s[12:15], s30 offen lds
  s_add_u32 m0, s32, 65536
  s_nop 0
  buffer_load_dwordx4 v6, s[12:15], s30 offen lds
  s_add_u32 m0, s32, 69632
  s_nop 0
  buffer_load_dwordx4 v7, s[12:15], s30 offen lds
  s_add_u32 s30, s30, 81920
  s_add_u32 m0, s64, 115712
  s_mov_b64 exec, s[66:67]
  buffer_load_dwordx4 v8, s[16:19], s31 offen lds
  s_add_u32 m0, s64, 118272
  s_nop 0
  buffer_load_dwordx4 v8, s[56:59], s31 offen lds
  s_mov_b64 exec, -1
  s_add_u32 s31, s31, 2560
  s_add_u32 m0, s32, 73728
  s_nop 0
  buffer_load_dwordx4 v2, s[8:11], s29 offen lds
  s_add_u32 m0, s32, 77824
  s_nop 0
  buffer_load_dwordx4 v14, s[8:11], s29 offen lds
  s_add_u32 m0, s32, 81920
  s_nop 0
  buffer_load_dwordx4 v15, s[8:11], s29 offen lds
  s_add_u32 m0, s32, 86016
  s_nop 0
  buffer_load_dwordx4 v16, s[8:11], s29 offen lds
  s_add_u32 m0, s32, 90112
  s_add_u32 s29, s29, 128
  buffer_load_dwordx4 v3, s[12:15], s30 offen lds
  s_add_u32 m0, s32, 94208
  s_nop 0
  buffer_load_dwordx4 v4, s[12:15], s30 offen lds
  s_add_u32 m0, s32, 98304
  s_nop 0
  buffer_load_dwordx4 v5, s[12:15], s30 offen lds
  s_add_u32 m0, s32, 102400
  s_nop 0
  buffer_load_dwordx4 v6, s[12:15], s30 offen lds
  s_add_u32 m0, s32, 106496
  s_nop 0
  buffer_load_dwordx4 v7, s[12:15], s30 offen lds
  s_add_u32 s30, s30, 81920
  s_add_u32 m0, s64, 120832
  s_mov_b64 exec, s[66:67]
  buffer_load_dwordx4 v8, s[16:19], s31 offen lds
  s_add_u32 m0, s64, 123392
  s_nop 0
  buffer_load_dwordx4 v8, s[56:59], s31 offen lds
  s_mov_b64 exec, -1
  s_add_u32 s31, s31, 2560
  s_cmp_eq_u32 s20, 1
  s_cselect_b32 s36, s36, s46
  s_cselect_b32 s37, s37, s47
  s_lshl_b32 s38, s55, 10
  s_lshl_b32 s39, s54, 5
  s_add_u32 s38, s38, s39
  s_lshl_b32 s39, s26, 3
  s_add_u32 s38, s38, s39
  s_mul_i32 s38, s38, 1280
  s_add_u32 s60, s36, s38
  s_addc_u32 s61, s37, 0
  s_and_b32 s61, s61, 0xffff
  s_mov_b32 s62, 10240
  s_mov_b32 s63, 0x20000
  v_and_b32 v10, 7, v1
  v_mul_u32_u24 v10, 1280, v10
  v_lshrrev_b32 v11, 3, v1
  v_lshl_add_u32 v17, v11, 7, v10
  s_mul_i32 s38, s68, 1280
  s_mul_i32 s39, s22, 320
  s_sub_u32 s38, s39, s38
  s_sub_u32 s48, s12, s38
  s_subb_u32 s49, s13, 0
  s_and_b32 s49, s49, 0xffff
  s_add_u32 s50, s14, s38
  s_mov_b32 s51, 0x20000
  s_movk_i32 s38, 13108
  v_mul_lo_u32 v11, v1, s38
  v_lshrrev_b32 v11, 16, v11
  v_mul_u32_u24 v12, 5, v11
  v_sub_u32 v12, v1, v12
  s_mul_i32 s38, s54, 20
  s_mul_i32 s39, s26, 5
  s_add_u32 s38, s38, s39
  v_add_u32 v12, s38, v12
  s_movk_i32 s38, 6554
  v_mul_lo_u32 v13, v12, s38
  v_lshrrev_b32 v13, 16, v13
  v_mul_u32_u24 v9, 10, v13
  v_sub_u32 v9, v12, v9
  v_lshl_add_u32 v13, v11, 6, v13
  s_movk_i32 s38, 1280
  v_mul_lo_u32 v13, v13, s38
  v_lshl_add_u32 v18, v9, 7, v13
  s_mov_b32 exec_lo, 0xffff
  s_mov_b32 exec_hi, 0x0
  s_mov_b32 s38, 384
  buffer_load_dword v63, v17, s[60:63], s38 offen
  s_mov_b32 exec_lo, 0x3ff
  s_mov_b32 exec_hi, 0x0
  s_mov_b32 s38, 245760
  buffer_load_dword v62, v18, s[48:51], s38 offen
  s_mov_b64 exec, -1
  s_lshl_b32 s38, s54, 2
  s_add_u32 s38, s38, s26
  s_lshl_b32 s38, s38, 1
  v_and_b32 v10, 1, v1
  v_add_u32 v10, s38, v10
  v_lshlrev_b32 v10, 7, v10
  s_mov_b64 exec, 3
  buffer_load_dword v61, v10, s[16:19], 0 offen
  buffer_load_dword v60, v10, s[56:59], 0 offen
  s_mov_b64 exec, -1
  s_waitcnt vmcnt(26)
  s_barrier
  s_mov_b32 exec_lo, 0xffff
  s_mov_b32 exec_hi, 0x0
  s_mov_b32 s38, 640
  buffer_load_dword v63, v17, s[60:63], s38 offen
  s_mov_b32 exec_lo, 0x3ff
  s_mov_b32 exec_hi, 0x0
  s_mov_b32 s38, 409600
  buffer_load_dword v62, v18, s[48:51], s38 offen
  s_mov_b64 exec, -1
  s_waitcnt vmcnt(17)
  s_barrier
  s_mov_b32 exec_lo, 0xffffff
  s_mov_b32 exec_hi, 0x0
  s_mov_b32 s38, 896
  buffer_load_dword v63, v17, s[60:63], s38 offen
  s_mov_b32 exec_lo, 0x7fff
  s_mov_b32 exec_hi, 0x0
  s_mov_b32 s38, 573440
  buffer_load_dword v62, v18, s[48:51], s38 offen
  s_mov_b64 exec, -1
  s_add_u32 m0, s32, 0
  s_nop 0
  buffer_load_dwordx4 v2, s[8:11], s29 offen lds
  s_add_u32 m0, s32, 4096
  s_nop 0
  buffer_load_dwordx4 v14, s[8:11], s29 offen lds
  s_add_u32 m0, s32, 8192
  s_nop 0
  buffer_load_dwordx4 v15, s[8:11], s29 offen lds
  s_add_u32 m0, s32, 12288
  s_nop 0
  buffer_load_dwordx4 v16, s[8:11], s29 offen lds
  s_add_u32 m0, s32, 16384
  s_add_u32 s29, s29, 128
  buffer_load_dwordx4 v3, s[12:15], s30 offen lds
  s_add_u32 m0, s32, 20480
  s_nop 0
  buffer_load_dwordx4 v4, s[12:15], s30 offen lds
  s_add_u32 m0, s32, 24576
  s_nop 0
  buffer_load_dwordx4 v5, s[12:15], s30 offen lds
  s_add_u32 m0, s32, 28672
  s_nop 0
  buffer_load_dwordx4 v6, s[12:15], s30 offen lds
  s_add_u32 m0, s32, 32768
  s_nop 0
  buffer_load_dwordx4 v7, s[12:15], s30 offen lds
  s_add_u32 s30, s30, 81920
  s_add_u32 m0, s64, 110592
  s_mov_b64 exec, s[66:67]
  buffer_load_dwordx4 v8, s[16:19], s31 offen lds
  s_add_u32 m0, s64, 113152
  s_nop 0
  buffer_load_dwordx4 v8, s[56:59], s31 offen lds
  s_mov_b64 exec, -1
  s_add_u32 s31, s31, 2560
  s_waitcnt vmcnt(19)
  s_barrier
  s_add_u32 m0, s32, 36864
  s_nop 0
  buffer_load_dwordx4 v2, s[8:11], s29 offen lds
  s_add_u32 m0, s32, 40960
  s_nop 0
  buffer_load_dwordx4 v14, s[8:11], s29 offen lds
  s_add_u32 m0, s32, 45056
  s_nop 0
  buffer_load_dwordx4 v15, s[8:11], s29 offen lds
  s_add_u32 m0, s32, 49152
  s_nop 0
  buffer_load_dwordx4 v16, s[8:11], s29 offen lds
  s_add_u32 m0, s32, 53248
  s_add_u32 s29, s29, 128
  buffer_load_dwordx4 v3, s[12:15], s30 offen lds
  s_add_u32 m0, s32, 57344
  s_nop 0
  buffer_load_dwordx4 v4, s[12:15], s30 offen lds
  s_add_u32 m0, s32, 61440
  s_nop 0
  buffer_load_dwordx4 v5, s[12:15], s30 offen lds
  s_add_u32 m0, s32, 65536
  s_nop 0
  buffer_load_dwordx4 v6, s[12:15], s30 offen lds
  s_add_u32 m0, s32, 69632
  s_nop 0
  buffer_load_dwordx4 v7, s[12:15], s30 offen lds
  s_add_u32 s30, s30, 81920
  s_add_u32 m0, s64, 115712
  s_mov_b64 exec, s[66:67]
  buffer_load_dwordx4 v8, s[16:19], s31 offen lds
  s_add_u32 m0, s64, 118272
  s_nop 0
  buffer_load_dwordx4 v8, s[56:59], s31 offen lds
  s_mov_b64 exec, -1
  s_add_u32 s31, s31, 2560
  s_waitcnt vmcnt(11)
  s_barrier
  s_add_u32 m0, s32, 73728
  s_nop 0
  buffer_load_dwordx4 v2, s[8:11], s29 offen lds
  s_add_u32 m0, s32, 77824
  s_nop 0
  buffer_load_dwordx4 v14, s[8:11], s29 offen lds
  s_add_u32 m0, s32, 81920
  s_nop 0
  buffer_load_dwordx4 v15, s[8:11], s29 offen lds
  s_add_u32 m0, s32, 86016
  s_nop 0
  buffer_load_dwordx4 v16, s[8:11], s29 offen lds
  s_add_u32 m0, s32, 90112
  s_add_u32 s29, s29, 128
  buffer_load_dwordx4 v3, s[12:15], s30 offen lds
  s_add_u32 m0, s32, 94208
  s_nop 0
  buffer_load_dwordx4 v4, s[12:15], s30 offen lds
  s_add_u32 m0, s32, 98304
  s_nop 0
  buffer_load_dwordx4 v5, s[12:15], s30 offen lds
  s_add_u32 m0, s32, 102400
  s_nop 0
  buffer_load_dwordx4 v6, s[12:15], s30 offen lds
  s_add_u32 m0, s32, 106496
  s_nop 0
  buffer_load_dwordx4 v7, s[12:15], s30 offen lds
  s_add_u32 s30, s30, 81920
  s_add_u32 m0, s64, 120832
  s_mov_b64 exec, s[66:67]
  buffer_load_dwordx4 v8, s[16:19], s31 offen lds
  s_add_u32 m0, s64, 123392
  s_nop 0
  buffer_load_dwordx4 v8, s[56:59], s31 offen lds
  s_mov_b64 exec, -1
  s_add_u32 s31, s31, 2560
  s_waitcnt vmcnt(11)
  s_barrier
  s_add_u32 m0, s32, 0
  s_nop 0
  buffer_load_dwordx4 v2, s[8:11], s29 offen lds
  s_add_u32 m0, s32, 4096
  s_nop 0
  buffer_load_dwordx4 v14, s[8:11], s29 offen lds
  s_add_u32 m0, s32, 8192
  s_nop 0
  buffer_load_dwordx4 v15, s[8:11], s29 offen lds
  s_add_u32 m0, s32, 12288
  s_nop 0
  buffer_load_dwordx4 v16, s[8:11], s29 offen lds
  s_add_u32 m0, s32, 16384
  s_add_u32 s29, s29, 128
  buffer_load_dwordx4 v3, s[12:15], s30 offen lds
  s_add_u32 m0, s32, 20480
  s_nop 0
  buffer_load_dwordx4 v4, s[12:15], s30 offen lds
  s_add_u32 m0, s32, 24576
  s_nop 0
  buffer_load_dwordx4 v5, s[12:15], s30 offen lds
  s_add_u32 m0, s32, 28672
  s_nop 0
  buffer_load_dwordx4 v6, s[12:15], s30 offen lds
  s_add_u32 m0, s32, 32768
  s_nop 0
  buffer_load_dwordx4 v7, s[12:15], s30 offen lds
  s_add_u32 s30, s30, 81920
  s_add_u32 m0, s64, 110592
  s_mov_b64 exec, s[66:67]
  buffer_load_dwordx4 v8, s[16:19], s31 offen lds
  s_add_u32 m0, s64, 113152
  s_nop 0
  buffer_load_dwordx4 v8, s[56:59], s31 offen lds
  s_mov_b64 exec, -1
  s_add_u32 s31, s31, 2560
  s_waitcnt vmcnt(11)
  s_barrier
  s_add_u32 m0, s32, 36864
  s_nop 0
  buffer_load_dwordx4 v2, s[8:11], s29 offen lds
  s_add_u32 m0, s32, 40960
  s_nop 0
  buffer_load_dwordx4 v14, s[8:11], s29 offen lds
  s_add_u32 m0, s32, 45056
  s_nop 0
  buffer_load_dwordx4 v15, s[8:11], s29 offen lds
  s_add_u32 m0, s32, 49152
  s_nop 0
  buffer_load_dwordx4 v16, s[8:11], s29 offen lds
  s_add_u32 m0, s32, 53248
  s_add_u32 s29, s29, 128
  buffer_load_dwordx4 v3, s[12:15], s30 offen lds
  s_add_u32 m0, s32, 57344
  s_nop 0
  buffer_load_dwordx4 v4, s[12:15], s30 offen lds
  s_add_u32 m0, s32, 61440
  s_nop 0
  buffer_load_dwordx4 v5, s[12:15], s30 offen lds
  s_add_u32 m0, s32, 65536
  s_nop 0
  buffer_load_dwordx4 v6, s[12:15], s30 offen lds
  s_add_u32 m0, s32, 69632
  s_nop 0
  buffer_load_dwordx4 v7, s[12:15], s30 offen lds
  s_add_u32 s30, s30, 81920
  s_add_u32 m0, s64, 115712
  s_mov_b64 exec, s[66:67]
  buffer_load_dwordx4 v8, s[16:19], s31 offen lds
  s_add_u32 m0, s64, 118272
  s_nop 0
  buffer_load_dwordx4 v8, s[56:59], s31 offen lds
  s_mov_b64 exec, -1
  s_add_u32 s31, s31, 2560
  s_waitcnt vmcnt(11)
  s_barrier
  s_add_u32 m0, s32, 73728
  s_nop 0
  buffer_load_dwordx4 v2, s[8:11], s29 offen lds
  s_add_u32 m0, s32, 77824
  s_nop 0
  buffer_load_dwordx4 v14, s[8:11], s29 offen lds
  s_add_u32 m0, s32, 81920
  s_nop 0
  buffer_load_dwordx4 v15, s[8:11], s29 offen lds
  s_add_u32 m0, s32, 86016
  s_nop 0
  buffer_load_dwordx4 v16, s[8:11], s29 offen lds
  s_add_u32 m0, s32, 90112
  s_add_u32 s29, s29, 128
  buffer_load_dwordx4 v3, s[12:15], s30 offen lds
  s_add_u32 m0, s32, 94208
  s_nop 0
  buffer_load_dwordx4 v4, s[12:15], s30 offen lds
  s_add_u32 m0, s32, 98304
  s_nop 0
  buffer_load_dwordx4 v5, s[12:15], s30 offen lds
  s_add_u32 m0, s32, 102400
  s_nop 0
  buffer_load_dwordx4 v6, s[12:15], s30 offen lds
  s_add_u32 m0, s32, 106496
  s_nop 0
  buffer_load_dwordx4 v7, s[12:15], s30 offen lds
  s_add_u32 s30, s30, 81920
  s_add_u32 m0, s64, 120832
  s_mov_b64 exec, s[66:67]
  buffer_load_dwordx4 v8, s[16:19], s31 offen lds
  s_add_u32 m0, s64, 123392
  s_nop 0
  buffer_load_dwordx4 v8, s[56:59], s31 offen lds
  s_mov_b64 exec, -1
  s_add_u32 s31, s31, 2560
  s_waitcnt vmcnt(11)
  s_barrier
  s_add_u32 m0, s32, 0
  s_nop 0
  buffer_load_dwordx4 v2, s[8:11], s29 offen lds
  s_add_u32 m0, s32, 4096
  s_nop 0
  buffer_load_dwordx4 v14, s[8:11], s29 offen lds
  s_add_u32 m0, s32, 8192
  s_nop 0
  buffer_load_dwordx4 v15, s[8:11], s29 offen lds
  s_add_u32 m0, s32, 12288
  s_nop 0
  buffer_load_dwordx4 v16, s[8:11], s29 offen lds
  s_add_u32 m0, s32, 16384
  s_add_u32 s29, s29, 128
  buffer_load_dwordx4 v3, s[12:15], s30 offen lds
  s_add_u32 m0, s32, 20480
  s_nop 0
  buffer_load_dwordx4 v4, s[12:15], s30 offen lds
  s_add_u32 m0, s32, 24576
  s_nop 0
  buffer_load_dwordx4 v5, s[12:15], s30 offen lds
  s_add_u32 m0, s32, 28672
  s_nop 0
  buffer_load_dwordx4 v6, s[12:15], s30 offen lds
  s_add_u32 m0, s32, 32768
  s_nop 0
  buffer_load_dwordx4 v7, s[12:15], s30 offen lds
  s_add_u32 s30, s30, 81920
  s_add_u32 m0, s64, 110592
  s_mov_b64 exec, s[66:67]
  buffer_load_dwordx4 v8, s[16:19], s31 offen lds
  s_add_u32 m0, s64, 113152
  s_nop 0
  buffer_load_dwordx4 v8, s[56:59], s31 offen lds
  s_mov_b64 exec, -1
  s_add_u32 s31, s31, 2560
  s_waitcnt vmcnt(11)
  s_barrier
  s_waitcnt vmcnt(0)
  s_barrier
  s_lshl_b32 s27, s21, 2
  s_cmp_eq_u32 s23, 0
  s_cbranch_scc0 L_k1_cs_kvx
  s_xor_b32 s28, s20, 1
  s_lshl_b32 s28, s28, 5
  s_lshl_b32 s29, s24, 3
  s_add_u32 s28, s28, s29
  s_mul_i32 s28, s28, 81920
  s_add_u32 s28, s28, 6291456
  s_mov_b32 s30, 81920
  s_mov_b32 s33, 1280
  s_mov_b32 s34, 0
  s_branch L_k1_cs_donex
L_k1_cs_kvx:
  s_lshl_b32 s29, s24, 3
  s_mul_i32 s28, s29, 163840
  s_add_u32 s28, s28, 0
  s_mov_b32 s30, 163840
  s_mov_b32 s33, 2560
  s_cmp_eq_u32 s23, 2
  s_cselect_b32 s34, 1280, 0
L_k1_cs_donex:
  s_mul_i32 s27, s27, s33
  s_add_u32 s27, s27, s34
  s_add_u32 s28, s28, s27
  s_add_u32 s60, s52, s28
  s_addc_u32 s61, s53, 0
  s_and_b32 s61, s61, 0xffff
  s_lshl_b32 s29, s30, 3
  s_sub_u32 s62, s29, s27
  s_mov_b32 s63, 0x20000
  s_lshl_b32 s27, s25, 6
  v_add_u32 v11, s27, v1
  v_lshlrev_b32 v12, 4, v11
  v_add_u32 v41, 36864, v12
  s_movk_i32 s27, 3277
  v_add_u32 v12, 0, v11
  v_mul_lo_u32 v13, v12, s27
  v_lshrrev_b32 v13, 18, v13
  v_mul_u32_u24 v14, 80, v13
  v_sub_u32 v14, v12, v14
  v_lshrrev_b32 v15, 2, v13
  v_mul_lo_u32 v15, v15, s30
  v_and_b32 v13, 3, v13
  v_mul_lo_u32 v13, v13, s33
  v_lshl_add_u32 v14, v14, 4, v15
  v_add_u32 v36, v14, v13
  v_add_u32 v12, 512, v11
  v_mul_lo_u32 v13, v12, s27
  v_lshrrev_b32 v13, 18, v13
  v_mul_u32_u24 v14, 80, v13
  v_sub_u32 v14, v12, v14
  v_lshrrev_b32 v15, 2, v13
  v_mul_lo_u32 v15, v15, s30
  v_and_b32 v13, 3, v13
  v_mul_lo_u32 v13, v13, s33
  v_lshl_add_u32 v14, v14, 4, v15
  v_add_u32 v37, v14, v13
  v_add_u32 v12, 1024, v11
  v_mul_lo_u32 v13, v12, s27
  v_lshrrev_b32 v13, 18, v13
  v_mul_u32_u24 v14, 80, v13
  v_sub_u32 v14, v12, v14
  v_lshrrev_b32 v15, 2, v13
  v_mul_lo_u32 v15, v15, s30
  v_and_b32 v13, 3, v13
  v_mul_lo_u32 v13, v13, s33
  v_lshl_add_u32 v14, v14, 4, v15
  v_add_u32 v38, v14, v13
  v_add_u32 v12, 1536, v11
  v_mul_lo_u32 v13, v12, s27
  v_lshrrev_b32 v13, 18, v13
  v_mul_u32_u24 v14, 80, v13
  v_sub_u32 v14, v12, v14
  v_lshrrev_b32 v15, 2, v13
  v_mul_lo_u32 v15, v15, s30
  v_and_b32 v13, 3, v13
  v_mul_lo_u32 v13, v13, s33
  v_lshl_add_u32 v14, v14, 4, v15
  v_add_u32 v39, v14, v13
  v_add_u32 v12, 2048, v11
  v_mul_lo_u32 v13, v12, s27
  v_lshrrev_b32 v13, 18, v13
  v_mul_u32_u24 v14, 80, v13
  v_sub_u32 v14, v12, v14
  v_lshrrev_b32 v15, 2, v13
  v_mul_lo_u32 v15, v15, s30
  v_and_b32 v13, 3, v13
  v_mul_lo_u32 v13, v13, s33
  v_lshl_add_u32 v14, v14, 4, v15
  v_add_u32 v40, v14, v13
  s_add_u32 s56, s52, 5242880
  s_addc_u32 s57, s53, 0
  s_and_b32 s57, s57, 0xffff
  s_mov_b32 s58, 163840
  s_mov_b32 s59, 0x20000
  s_lshl_b32 s69, s21, 2
  s_add_u32 s69, s69, s22
  s_mul_i32 s69, s69, 2560
  v_lshlrev_b32 v42, 4, v11
  s_branch L_k1_copy
L_k1_consumer:
  s_cmp_eq_u32 s2, 0
  s_cbranch_scc0 L_k1_noflag
  s_cmp_eq_u32 s25, 0
  s_cbranch_scc0 L_k1_noflag
  s_add_u32 s56, s52, 18874368
  s_addc_u32 s57, s53, 0
  s_and_b32 s57, s57, 0xffff
  s_mov_b32 s58, 1024
  s_mov_b32 s59, 0x20000
  v_lshlrev_b32 v11, 4, v1
  v_mov_b32 v24, 0
  v_mov_b32 v25, 0
  v_mov_b32 v26, 0
  v_mov_b32 v27, 0
  buffer_store_dwordx4 v[24:27], v11, s[56:59], 0 offen
L_k1_noflag:
  s_cmp_eq_u32 s25, 3
  s_cbranch_scc0 L_k1_nocpf2
  s_getpc_b64 s[26:27]
L_pc_2:
  s_add_u32 s26, s26, attn_kernel-L_pc_2
  s_addc_u32 s27, s27, 0
  v_lshlrev_b32 v11, 7, v1
  v_min_u32 v11, L_k2_hotend-attn_kernel-4, v11
  global_load_dword v63, v11, s[26:27]
  v_lshlrev_b32 v11, 7, v1
  v_add_u32 v11, 8192, v11
  v_min_u32 v11, L_k2_hotend-attn_kernel-4, v11
  global_load_dword v63, v11, s[26:27]
L_k1_nocpf2:
  v_and_b32 v11, 15, v1
  v_lshrrev_b32 v12, 4, v1
  s_lshr_b32 s26, s25, 1
  s_and_b32 s27, s25, 1
  s_lshl_b32 s28, s26, 6
  v_add_u32 v13, s28, v11
  v_lshlrev_b32 v13, 7, v13
  v_lshrrev_b32 v14, 1, v11
  v_xor_b32 v14, v14, v12
  v_lshlrev_b32 v14, 4, v14
  v_add_u32 v4, v13, v14
  v_xor_b32 v5, 64, v4
  s_lshl_b32 s28, s22, 5
  s_lshl_b32 s29, s27, 4
  s_add_u32 s28, s28, s29
  v_add_u32 v13, s28, v11
  v_lshlrev_b32 v13, 7, v13
  v_add_u32 v8, v13, v14
  v_xor_b32 v9, 64, v8
  v_lshrrev_b32 v13, 2, v11
  v_lshl_add_u32 v13, v12, 3, v13
  v_mul_u32_u24 v15, 320, v13
  v_and_b32 v14, 3, v11
  v_lshl_add_u32 v15, v14, 3, v15
  s_mul_i32 s28, s27, 160
  s_add_u32 s28, s28, 16384
  v_add_u32 v15, s28, v15
  v_and_b32 v16, 1, v12
  v_lshlrev_b32 v16, 5, v16
  v_add_u32 v17, v15, v16
  v_sub_u32 v18, v15, v16
  s_cmp_eq_u32 s27, 0
  s_cselect_b64 vcc, -1, 0
  v_cndmask_b32 v6, v18, v17, vcc
  v_cndmask_b32 v7, v17, v18, vcc
  v_mul_u32_u24 v15, 40, v13
  v_lshl_add_u32 v15, v14, 3, v15
  s_cmp_ge_u32 s25, 2
  s_mov_b32 s28, 110592
  s_cselect_b32 s28, 113152, s28
  v_add_u32 v10, s28, v15
  v_mov_b32 v64, 0
  v_mov_b32 v65, 0
  v_mov_b32 v66, 0
  v_mov_b32 v67, 0
  v_mov_b32 v68, 0
  v_mov_b32 v69, 0
  v_mov_b32 v70, 0
  v_mov_b32 v71, 0
  v_mov_b32 v72, 0
  v_mov_b32 v73, 0
  v_mov_b32 v74, 0
  v_mov_b32 v75, 0
  v_mov_b32 v76, 0
  v_mov_b32 v77, 0
  v_mov_b32 v78, 0
  v_mov_b32 v79, 0
  v_mov_b32 v80, 0
  v_mov_b32 v81, 0
  v_mov_b32 v82, 0
  v_mov_b32 v83, 0
  v_mov_b32 v84, 0
  v_mov_b32 v85, 0
  v_mov_b32 v86, 0
  v_mov_b32 v87, 0
  v_mov_b32 v88, 0
  v_mov_b32 v89, 0
  v_mov_b32 v90, 0
  v_mov_b32 v91, 0
  v_mov_b32 v92, 0
  v_mov_b32 v93, 0
  v_mov_b32 v94, 0
  v_mov_b32 v95, 0
  v_mov_b32 v96, 0
  v_mov_b32 v97, 0
  v_mov_b32 v98, 0
  v_mov_b32 v99, 0
  v_mov_b32 v100, 0
  v_mov_b32 v101, 0
  v_mov_b32 v102, 0
  v_mov_b32 v103, 0
  v_mov_b32 v104, 0
  v_mov_b32 v105, 0
  v_mov_b32 v106, 0
  v_mov_b32 v107, 0
  v_mov_b32 v108, 0
  v_mov_b32 v109, 0
  v_mov_b32 v110, 0
  v_mov_b32 v111, 0
  v_mov_b32 v112, 0
  v_mov_b32 v113, 0
  v_mov_b32 v114, 0
  v_mov_b32 v115, 0
  v_mov_b32 v116, 0
  v_mov_b32 v117, 0
  v_mov_b32 v118, 0
  v_mov_b32 v119, 0
  v_mov_b32 v120, 0
  v_mov_b32 v121, 0
  v_mov_b32 v122, 0
  v_mov_b32 v123, 0
  v_mov_b32 v124, 0
  v_mov_b32 v125, 0
  v_mov_b32 v126, 0
  v_mov_b32 v127, 0
  v_mov_b32 v128, 0
  v_mov_b32 v129, 0
  v_mov_b32 v130, 0
  v_mov_b32 v131, 0
  v_mov_b32 v132, 0
  v_mov_b32 v133, 0
  v_mov_b32 v134, 0
  v_mov_b32 v135, 0
  v_mov_b32 v136, 0
  v_mov_b32 v137, 0
  v_mov_b32 v138, 0
  v_mov_b32 v139, 0
  v_mov_b32 v140, 0
  v_mov_b32 v141, 0
  v_mov_b32 v142, 0
  v_mov_b32 v143, 0
  v_mov_b32 v144, 0
  v_mov_b32 v145, 0
  v_mov_b32 v146, 0
  v_mov_b32 v147, 0
  v_mov_b32 v148, 0
  v_mov_b32 v149, 0
  v_mov_b32 v150, 0
  v_mov_b32 v151, 0
  s_lshr_b32 s26, s25, 1
  s_lshl_b32 s27, s21, 2
  s_lshl_b32 s28, s26, 1
  s_add_u32 s27, s27, s28
  v_and_b32 v11, 15, v1
  s_cmp_eq_u32 s23, 0
  s_cbranch_scc0 L_k1_par_kv
  s_xor_b32 s28, s20, 1
  s_lshl_b32 s28, s28, 5
  s_lshl_b32 s29, s24, 3
  s_add_u32 s28, s28, s29
  s_mul_i32 s28, s28, 81920
  s_add_u32 s28, s28, 6291456
  s_mov_b32 s62, 655360
  s_mov_b32 s30, 5120
  s_mul_i32 s31, s27, 1280
  s_add_u32 s32, s31, 1280
  s_mov_b32 s33, 16
  s_mov_b32 s34, 0x3ea52b59
  s_branch L_k1_par_done
L_k1_par_kv:
  s_lshl_b32 s29, s24, 3
  s_mul_i32 s28, s29, 163840
  s_add_u32 s28, s28, 0
  s_mov_b32 s62, 1310720
  s_mov_b32 s30, 5120
  s_mul_i32 s31, s27, 2560
  s_add_u32 s32, s31, 2560
  s_mov_b32 s33, 4
  s_mov_b32 s34, 1.0
  v_lshrrev_b32 v12, 2, v11
  v_lshlrev_b32 v12, 3, v12
  v_and_b32 v11, 3, v11
  v_add_u32 v11, v11, v12
L_k1_par_done:
  s_add_u32 s60, s52, s28
  s_addc_u32 s61, s53, 0
  s_and_b32 s61, s61, 0xffff
  s_mov_b32 s63, 0x20000
  s_mul_i32 s35, s26, 2560
  s_add_u32 s35, s35, 36864
  s_cmp_eq_u32 s23, 2
  s_cbranch_scc1 L_k1_c_V
  v_lshrrev_b32 v12, 4, v1
  v_lshlrev_b32 v12, 2, v12
  s_and_b32 s28, s25, 1
  s_mul_i32 s28, s28, 80
  v_add_u32 v12, s28, v12
  v_add_u32 v13, 0, v12
  s_movk_i32 s29, 205
  v_mul_lo_u32 v14, v13, s29
  v_lshrrev_b32 v14, 12, v14
  v_mul_u32_u24 v15, 20, v14
  v_sub_u32 v15, v13, v15
  v_mul_lo_u32 v14, v14, s30
  v_lshrrev_b32 v16, 3, v15
  v_lshlrev_b32 v16, 9, v16
  v_and_b32 v17, 4, v15
  v_lshl_add_u32 v16, v17, 1, v16
  v_cmp_gt_u32 vcc, 16, v15
  v_mov_b32 v18, 3
  v_mov_b32 v19, 4
  v_cndmask_b32 v18, v18, v19, vcc
  v_lshlrev_b32 v17, v18, v11
  v_add3_u32 v24, v14, v16, v17
  v_add_u32 v24, s35, v24
  v_lshlrev_b32 v17, v18, s33
  v_add_u32 v29, v24, v17
  v_add_u32 v13, 16, v12
  s_movk_i32 s29, 205
  v_mul_lo_u32 v14, v13, s29
  v_lshrrev_b32 v14, 12, v14
  v_mul_u32_u24 v15, 20, v14
  v_sub_u32 v15, v13, v15
  v_mul_lo_u32 v14, v14, s30
  v_lshrrev_b32 v16, 3, v15
  v_lshlrev_b32 v16, 9, v16
  v_and_b32 v17, 4, v15
  v_lshl_add_u32 v16, v17, 1, v16
  v_cmp_gt_u32 vcc, 16, v15
  v_mov_b32 v18, 3
  v_mov_b32 v19, 4
  v_cndmask_b32 v18, v18, v19, vcc
  v_lshlrev_b32 v17, v18, v11
  v_add3_u32 v25, v14, v16, v17
  v_add_u32 v25, s35, v25
  v_lshlrev_b32 v17, v18, s33
  v_add_u32 v30, v25, v17
  v_add_u32 v13, 32, v12
  s_movk_i32 s29, 205
  v_mul_lo_u32 v14, v13, s29
  v_lshrrev_b32 v14, 12, v14
  v_mul_u32_u24 v15, 20, v14
  v_sub_u32 v15, v13, v15
  v_mul_lo_u32 v14, v14, s30
  v_lshrrev_b32 v16, 3, v15
  v_lshlrev_b32 v16, 9, v16
  v_and_b32 v17, 4, v15
  v_lshl_add_u32 v16, v17, 1, v16
  v_cmp_gt_u32 vcc, 16, v15
  v_mov_b32 v18, 3
  v_mov_b32 v19, 4
  v_cndmask_b32 v18, v18, v19, vcc
  v_lshlrev_b32 v17, v18, v11
  v_add3_u32 v26, v14, v16, v17
  v_add_u32 v26, s35, v26
  v_lshlrev_b32 v17, v18, s33
  v_add_u32 v31, v26, v17
  v_add_u32 v13, 48, v12
  s_movk_i32 s29, 205
  v_mul_lo_u32 v14, v13, s29
  v_lshrrev_b32 v14, 12, v14
  v_mul_u32_u24 v15, 20, v14
  v_sub_u32 v15, v13, v15
  v_mul_lo_u32 v14, v14, s30
  v_lshrrev_b32 v16, 3, v15
  v_lshlrev_b32 v16, 9, v16
  v_and_b32 v17, 4, v15
  v_lshl_add_u32 v16, v17, 1, v16
  v_cmp_gt_u32 vcc, 16, v15
  v_mov_b32 v18, 3
  v_mov_b32 v19, 4
  v_cndmask_b32 v18, v18, v19, vcc
  v_lshlrev_b32 v17, v18, v11
  v_add3_u32 v27, v14, v16, v17
  v_add_u32 v27, s35, v27
  v_lshlrev_b32 v17, v18, s33
  v_add_u32 v32, v27, v17
  v_add_u32 v13, 64, v12
  s_movk_i32 s29, 205
  v_mul_lo_u32 v14, v13, s29
  v_lshrrev_b32 v14, 12, v14
  v_mul_u32_u24 v15, 20, v14
  v_sub_u32 v15, v13, v15
  v_mul_lo_u32 v14, v14, s30
  v_lshrrev_b32 v16, 3, v15
  v_lshlrev_b32 v16, 9, v16
  v_and_b32 v17, 4, v15
  v_lshl_add_u32 v16, v17, 1, v16
  v_cmp_gt_u32 vcc, 16, v15
  v_mov_b32 v18, 3
  v_mov_b32 v19, 4
  v_cndmask_b32 v18, v18, v19, vcc
  v_lshlrev_b32 v17, v18, v11
  v_add3_u32 v28, v14, v16, v17
  v_add_u32 v28, s35, v28
  v_lshlrev_b32 v17, v18, s33
  v_add_u32 v33, v28, v17
  s_mov_b32 s65, s34
  s_lshl_b32 s27, s21, 2
  s_cmp_eq_u32 s23, 0
  s_cbranch_scc0 L_k1_cs_kvxx
  s_xor_b32 s28, s20, 1
  s_lshl_b32 s28, s28, 5
  s_lshl_b32 s29, s24, 3
  s_add_u32 s28, s28, s29
  s_mul_i32 s28, s28, 81920
  s_add_u32 s28, s28, 6291456
  s_mov_b32 s30, 81920
  s_mov_b32 s33, 1280
  s_mov_b32 s34, 0
  s_branch L_k1_cs_donexx
L_k1_cs_kvxx:
  s_lshl_b32 s29, s24, 3
  s_mul_i32 s28, s29, 163840
  s_add_u32 s28, s28, 0
  s_mov_b32 s30, 163840
  s_mov_b32 s33, 2560
  s_cmp_eq_u32 s23, 2
  s_cselect_b32 s34, 1280, 0
L_k1_cs_donexx:
  s_mul_i32 s27, s27, s33
  s_add_u32 s27, s27, s34
  s_add_u32 s28, s28, s27
  s_add_u32 s60, s52, s28
  s_addc_u32 s61, s53, 0
  s_and_b32 s61, s61, 0xffff
  s_lshl_b32 s29, s30, 3
  s_sub_u32 s62, s29, s27
  s_mov_b32 s63, 0x20000
  s_lshl_b32 s27, s25, 6
  v_add_u32 v11, s27, v1
  v_lshlrev_b32 v12, 4, v11
  v_add_u32 v41, 36864, v12
  s_movk_i32 s27, 3277
  v_add_u32 v12, 0, v11
  v_mul_lo_u32 v13, v12, s27
  v_lshrrev_b32 v13, 18, v13
  v_mul_u32_u24 v14, 80, v13
  v_sub_u32 v14, v12, v14
  v_lshrrev_b32 v15, 2, v13
  v_mul_lo_u32 v15, v15, s30
  v_and_b32 v13, 3, v13
  v_mul_lo_u32 v13, v13, s33
  v_lshl_add_u32 v14, v14, 4, v15
  v_add_u32 v36, v14, v13
  v_add_u32 v12, 512, v11
  v_mul_lo_u32 v13, v12, s27
  v_lshrrev_b32 v13, 18, v13
  v_mul_u32_u24 v14, 80, v13
  v_sub_u32 v14, v12, v14
  v_lshrrev_b32 v15, 2, v13
  v_mul_lo_u32 v15, v15, s30
  v_and_b32 v13, 3, v13
  v_mul_lo_u32 v13, v13, s33
  v_lshl_add_u32 v14, v14, 4, v15
  v_add_u32 v37, v14, v13
  v_add_u32 v12, 1024, v11
  v_mul_lo_u32 v13, v12, s27
  v_lshrrev_b32 v13, 18, v13
  v_mul_u32_u24 v14, 80, v13
  v_sub_u32 v14, v12, v14
  v_lshrrev_b32 v15, 2, v13
  v_mul_lo_u32 v15, v15, s30
  v_and_b32 v13, 3, v13
  v_mul_lo_u32 v13, v13, s33
  v_lshl_add_u32 v14, v14, 4, v15
  v_add_u32 v38, v14, v13
  v_add_u32 v12, 1536, v11
  v_mul_lo_u32 v13, v12, s27
  v_lshrrev_b32 v13, 18, v13
  v_mul_u32_u24 v14, 80, v13
  v_sub_u32 v14, v12, v14
  v_lshrrev_b32 v15, 2, v13
  v_mul_lo_u32 v15, v15, s30
  v_and_b32 v13, 3, v13
  v_mul_lo_u32 v13, v13, s33
  v_lshl_add_u32 v14, v14, 4, v15
  v_add_u32 v39, v14, v13
  v_add_u32 v12, 2048, v11
  v_mul_lo_u32 v13, v12, s27
  v_lshrrev_b32 v13, 18, v13
  v_mul_u32_u24 v14, 80, v13
  v_sub_u32 v14, v12, v14
  v_lshrrev_b32 v15, 2, v13
  v_mul_lo_u32 v15, v15, s30
  v_and_b32 v13, 3, v13
  v_mul_lo_u32 v13, v13, s33
  v_lshl_add_u32 v14, v14, 4, v15
  v_add_u32 v40, v14, v13
  s_add_u32 s56, s52, 5242880
  s_addc_u32 s57, s53, 0
  s_and_b32 s57, s57, 0xffff
  s_mov_b32 s58, 163840
  s_mov_b32 s59, 0x20000
  s_lshl_b32 s69, s21, 2
  s_add_u32 s69, s69, s22
  s_mul_i32 s69, s69, 2560
  v_lshlrev_b32 v42, 4, v11
  s_mov_b32 s34, s65
  s_cmp_eq_u32 s20, 1
  s_cbranch_scc1 L_k1_c_A
  s_barrier
  ds_read_b128 v[152:155], v4 offset:0
  ds_read_b128 v[156:159], v4 offset:2048
  ds_read_b128 v[160:163], v4 offset:4096
  ds_read_b128 v[164:167], v4 offset:6144
  ds_read_b64_tr_b16 v[168:169], v6 offset:0
  ds_read_b64_tr_b16 v[170:171], v6 offset:1280
  ds_read_b64_tr_b16 v[172:173], v7 offset:32
  ds_read_b64_tr_b16 v[174:175], v7 offset:1312
  ds_read_b64_tr_b16 v[176:177], v6 offset:64
  ds_read_b64_tr_b16 v[178:179], v6 offset:1344
  ds_read_b64_tr_b16 v[180:181], v7 offset:96
  ds_read_b64_tr_b16 v[182:183], v7 offset:1376
  ds_read_b64_tr_b16 v[184:185], v6 offset:128
  ds_read_b64_tr_b16 v[186:187], v6 offset:1408
  s_mov_b32 s26, 0
  s_mov_b32 s27, 0
  s_mov_b32 s66, 36864
  s_mov_b32 s67, 4294893568
  s_mov_b32 s48, 0
  s_mov_b32 s49, 5120
  s_mov_b32 s50, 4294957056
.p2align 3
L_k1_cons_Q:
  s_waitcnt lgkmcnt(0)
  s_nop 0
  v_mfma_f32_16x16x32_bf16 v[64:67], v[168:171], v[152:155], v[64:67]
  ds_read_b64_tr_b16 v[216:217], v6 offset:10240
  s_add_u32 s27, s27, 1
  v_mfma_f32_16x16x32_bf16 v[68:71], v[168:171], v[156:159], v[68:71]
  ds_read_b64_tr_b16 v[218:219], v6 offset:11520
  s_cmp_eq_u32 s27, 3
  v_mfma_f32_16x16x32_bf16 v[72:75], v[168:171], v[160:163], v[72:75]
  ds_read_b64_tr_b16 v[220:221], v7 offset:10272
  s_cselect_b32 s28, s67, s66
  v_mfma_f32_16x16x32_bf16 v[76:79], v[168:171], v[164:167], v[76:79]
  ds_read_b64_tr_b16 v[222:223], v7 offset:11552
  s_cselect_b32 s27, 0, s27
  v_mfma_f32_16x16x32_bf16 v[80:83], v[172:175], v[152:155], v[80:83]
  ds_read_b64_tr_b16 v[224:225], v6 offset:10304
  v_add_u32 v4, s28, v4
  v_mfma_f32_16x16x32_bf16 v[84:87], v[172:175], v[156:159], v[84:87]
  ds_read_b64_tr_b16 v[226:227], v6 offset:11584
  v_mfma_f32_16x16x32_bf16 v[88:91], v[172:175], v[160:163], v[88:91]
  ds_read_b64_tr_b16 v[228:229], v7 offset:10336
  v_mfma_f32_16x16x32_bf16 v[92:95], v[172:175], v[164:167], v[92:95]
  ds_read_b64_tr_b16 v[230:231], v7 offset:11616
  v_mfma_f32_16x16x32_bf16 v[96:99], v[176:179], v[152:155], v[96:99]
  ds_read_b64_tr_b16 v[232:233], v6 offset:10368
  v_mfma_f32_16x16x32_bf16 v[100:103], v[176:179], v[156:159], v[100:103]
  ds_read_b64_tr_b16 v[234:235], v6 offset:11648
  v_mfma_f32_16x16x32_bf16 v[104:107], v[176:179], v[160:163], v[104:107]
  ds_read_b128 v[200:203], v5 offset:0
  v_add_u32 v6, s28, v6
  v_mfma_f32_16x16x32_bf16 v[108:111], v[176:179], v[164:167], v[108:111]
  ds_read_b128 v[204:207], v5 offset:2048
  v_add_u32 v7, s28, v7
  v_mfma_f32_16x16x32_bf16 v[112:115], v[180:183], v[152:155], v[112:115]
  ds_read_b128 v[208:211], v5 offset:4096
  v_mfma_f32_16x16x32_bf16 v[116:119], v[180:183], v[156:159], v[116:119]
  ds_read_b128 v[212:215], v5 offset:6144
  v_mfma_f32_16x16x32_bf16 v[120:123], v[180:183], v[160:163], v[120:123]
  v_mfma_f32_16x16x32_bf16 v[124:127], v[180:183], v[164:167], v[124:127]
  v_mfma_f32_16x16x32_bf16 v[128:131], v[184:187], v[152:155], v[128:131]
  v_mfma_f32_16x16x32_bf16 v[132:135], v[184:187], v[156:159], v[132:135]
  v_mfma_f32_16x16x32_bf16 v[136:139], v[184:187], v[160:163], v[136:139]
  s_cmp_eq_u32 s26, 9
  v_mfma_f32_16x16x32_bf16 v[140:143], v[184:187], v[164:167], v[140:143]
  s_waitcnt lgkmcnt(0)
  s_cbranch_scc1 L_k1_cons_Q_last
  s_barrier
  s_nop 0
  v_mfma_f32_16x16x32_bf16 v[64:67], v[216:219], v[200:203], v[64:67]
  ds_read_b128 v[152:155], v4 offset:0
  v_add_u32 v5, s28, v5
  v_mfma_f32_16x16x32_bf16 v[68:71], v[216:219], v[204:207], v[68:71]
  ds_read_b128 v[156:159], v4 offset:2048
  v_mfma_f32_16x16x32_bf16 v[72:75], v[216:219], v[208:211], v[72:75]
  ds_read_b128 v[160:163], v4 offset:4096
  s_add_u32 s26, s26, 1
  v_mfma_f32_16x16x32_bf16 v[76:79], v[216:219], v[212:215], v[76:79]
  ds_read_b128 v[164:167], v4 offset:6144
  v_mfma_f32_16x16x32_bf16 v[80:83], v[220:223], v[200:203], v[80:83]
  ds_read_b64_tr_b16 v[168:169], v6 offset:0
  v_mfma_f32_16x16x32_bf16 v[84:87], v[220:223], v[204:207], v[84:87]
  ds_read_b64_tr_b16 v[170:171], v6 offset:1280
  v_mfma_f32_16x16x32_bf16 v[88:91], v[220:223], v[208:211], v[88:91]
  ds_read_b64_tr_b16 v[172:173], v7 offset:32
  v_mfma_f32_16x16x32_bf16 v[92:95], v[220:223], v[212:215], v[92:95]
  ds_read_b64_tr_b16 v[174:175], v7 offset:1312
  v_mfma_f32_16x16x32_bf16 v[96:99], v[224:227], v[200:203], v[96:99]
  ds_read_b64_tr_b16 v[176:177], v6 offset:64
  v_mfma_f32_16x16x32_bf16 v[100:103], v[224:227], v[204:207], v[100:103]
  ds_read_b64_tr_b16 v[178:179], v6 offset:1344
  v_mfma_f32_16x16x32_bf16 v[104:107], v[224:227], v[208:211], v[104:107]
  ds_read_b64_tr_b16 v[180:181], v7 offset:96
  v_mfma_f32_16x16x32_bf16 v[108:111], v[224:227], v[212:215], v[108:111]
  ds_read_b64_tr_b16 v[182:183], v7 offset:1376
  v_mfma_f32_16x16x32_bf16 v[112:115], v[228:231], v[200:203], v[112:115]
  ds_read_b64_tr_b16 v[184:185], v6 offset:128
  v_mfma_f32_16x16x32_bf16 v[116:119], v[228:231], v[204:207], v[116:119]
  ds_read_b64_tr_b16 v[186:187], v6 offset:1408
  v_mfma_f32_16x16x32_bf16 v[120:123], v[228:231], v[208:211], v[120:123]
  v_mfma_f32_16x16x32_bf16 v[124:127], v[228:231], v[212:215], v[124:127]
  v_mfma_f32_16x16x32_bf16 v[128:131], v[232:235], v[200:203], v[128:131]
  v_mfma_f32_16x16x32_bf16 v[132:135], v[232:235], v[204:207], v[132:135]
  v_mfma_f32_16x16x32_bf16 v[136:139], v[232:235], v[208:211], v[136:139]
  v_mfma_f32_16x16x32_bf16 v[140:143], v[232:235], v[212:215], v[140:143]
  s_branch L_k1_cons_Q
L_k1_cons_Q_last:
  v_mfma_f32_16x16x32_bf16 v[64:67], v[216:219], v[200:203], v[64:67]
  v_mfma_f32_16x16x32_bf16 v[68:71], v[216:219], v[204:207], v[68:71]
  v_mfma_f32_16x16x32_bf16 v[72:75], v[216:219], v[208:211], v[72:75]
  v_mfma_f32_16x16x32_bf16 v[76:79], v[216:219], v[212:215], v[76:79]
  v_mfma_f32_16x16x32_bf16 v[80:83], v[220:223], v[200:203], v[80:83]
  v_mfma_f32_16x16x32_bf16 v[84:87], v[220:223], v[204:207], v[84:87]
  v_mfma_f32_16x16x32_bf16 v[88:91], v[220:223], v[208:211], v[88:91]
  v_mfma_f32_16x16x32_bf16 v[92:95], v[220:223], v[212:215], v[92:95]
  v_mfma_f32_16x16x32_bf16 v[96:99], v[224:227], v[200:203], v[96:99]
  v_mfma_f32_16x16x32_bf16 v[100:103], v[224:227], v[204:207], v[100:103]
  v_mfma_f32_16x16x32_bf16 v[104:107], v[224:227], v[208:211], v[104:107]
  v_mfma_f32_16x16x32_bf16 v[108:111], v[224:227], v[212:215], v[108:111]
  v_mfma_f32_16x16x32_bf16 v[112:115], v[228:231], v[200:203], v[112:115]
  v_mfma_f32_16x16x32_bf16 v[116:119], v[228:231], v[204:207], v[116:119]
  v_mfma_f32_16x16x32_bf16 v[120:123], v[228:231], v[208:211], v[120:123]
  v_mfma_f32_16x16x32_bf16 v[124:127], v[228:231], v[212:215], v[124:127]
  v_mfma_f32_16x16x32_bf16 v[128:131], v[232:235], v[200:203], v[128:131]
  v_mfma_f32_16x16x32_bf16 v[132:135], v[232:235], v[204:207], v[132:135]
  v_mfma_f32_16x16x32_bf16 v[136:139], v[232:235], v[208:211], v[136:139]
  v_mfma_f32_16x16x32_bf16 v[140:143], v[232:235], v[212:215], v[140:143]
  s_nop 7
  s_branch L_k1_epi_qk
L_k1_c_A:
  s_add_u32 s16, s52, 5242880
  s_addc_u32 s17, s53, 0
  s_and_b32 s17, s17, 0xffff
  s_mov_b32 s18, 163840
  s_mov_b32 s19, 0x20000
  s_lshl_b32 s35, s21, 2
  s_add_u32 s35, s35, s22
  s_mul_i32 s35, s35, 2560
  v_and_b32 v11, 15, v1
  v_lshrrev_b32 v12, 4, v1
  s_and_b32 s29, s25, 1
  s_lshl_b32 s29, s29, 2
  s_cmp_ge_u32 s25, 2
  s_cbranch_scc1 L_k1_xs_v
  v_lshrrev_b32 v13, 2, v11
  v_lshlrev_b32 v13, 3, v13
  v_and_b32 v14, 3, v11
  v_add3_u32 v13, v13, v14, s29
  v_lshrrev_b32 v14, 1, v12
  v_lshlrev_b32 v14, 9, v14
  v_and_b32 v15, 1, v12
  v_lshl_add_u32 v14, v15, 3, v14
  v_lshl_add_u32 v34, v13, 4, v14
  v_lshlrev_b32 v15, 3, v13
  v_add_u32 v35, 1024, v15
  s_branch L_k1_xs_done
L_k1_xs_v:
  v_lshrrev_b32 v13, 2, v11
  v_mul_u32_u24 v13, 320, v13
  v_and_b32 v14, 3, v11
  v_add_u32 v14, s29, v14
  v_lshl_add_u32 v13, v14, 1, v13
  v_add_u32 v35, 1280, v13
  v_lshlrev_b32 v14, 2, v12
  v_mov_b32 v16, 0
  v_cmp_le_u32 vcc, 4, v14
  s_nop 1
  v_cndmask_b32 v16, v16, 10, vcc
  v_cmp_le_u32 vcc, 8, v14
  s_nop 1
  v_cndmask_b32 v16, v16, 2, vcc
  v_cmp_le_u32 vcc, 12, v14
  s_nop 1
  v_cndmask_b32 v16, v16, -8, vcc
  v_cmp_le_u32 vcc, 16, v14
  s_nop 1
  v_cndmask_b32 v16, v16, 2, vcc
  v_cmp_le_u32 vcc, 18, v14
  s_nop 1
  v_cndmask_b32 v16, v16, -10, vcc
  v_add_u32 v15, v14, v16
  v_lshl_add_u32 v34, v15, 4, v35
L_k1_xs_done:
  v_add_u32 v34, 77824, v34
  v_add_u32 v35, 77824, v35
  s_barrier
  ds_read_b128 v[152:155], v4 offset:0
  ds_read_b128 v[156:159], v4 offset:2048
  ds_read_b128 v[160:163], v4 offset:4096
  ds_read_b128 v[164:167], v4 offset:6144
  ds_read_b64_tr_b16 v[168:169], v6 offset:0
  ds_read_b64_tr_b16 v[170:171], v6 offset:1280
  ds_read_b64_tr_b16 v[172:173], v7 offset:32
  ds_read_b64_tr_b16 v[174:175], v7 offset:1312
  ds_read_b64_tr_b16 v[176:177], v6 offset:64
  ds_read_b64_tr_b16 v[178:179], v6 offset:1344
  ds_read_b64_tr_b16 v[180:181], v7 offset:96
  ds_read_b64_tr_b16 v[182:183], v7 offset:1376
  ds_read_b64_tr_b16 v[184:185], v6 offset:128
  ds_read_b64_tr_b16 v[186:187], v6 offset:1408
  ds_read_b128 v[188:191], v8
  ds_read_b64_tr_b16 v[192:193], v10 offset:0
  ds_read_b64_tr_b16 v[194:195], v10 offset:160
  ds_read_b64_tr_b16 v[196:197], v10 offset:32
  ds_read_b64_tr_b16 v[198:199], v10 offset:192
  s_mov_b32 s26, 0
  s_mov_b32 s27, 0
  s_mov_b32 s66, 36864
  s_mov_b32 s67, 4294893568
  s_mov_b32 s48, 0
  s_mov_b32 s49, 5120
  s_mov_b32 s50, 4294957056
.p2align 3
L_k1_cons_A:
  s_waitcnt lgkmcnt(0)
  s_nop 0
  v_mfma_f32_16x16x32_bf16 v[64:67], v[168:171], v[152:155], v[64:67]
  ds_read_b64_tr_b16 v[216:217], v6 offset:10240
  s_add_u32 s27, s27, 1
  v_mfma_f32_16x16x32_bf16 v[68:71], v[168:171], v[156:159], v[68:71]
  ds_read_b64_tr_b16 v[218:219], v6 offset:11520
  s_cmp_eq_u32 s27, 3
  v_mfma_f32_16x16x32_bf16 v[72:75], v[168:171], v[160:163], v[72:75]
  ds_read_b64_tr_b16 v[220:221], v7 offset:10272
  s_cselect_b32 s28, s67, s66
  v_mfma_f32_16x16x32_bf16 v[76:79], v[168:171], v[164:167], v[76:79]
  ds_read_b64_tr_b16 v[222:223], v7 offset:11552
  s_cselect_b32 s27, 0, s27
  v_mfma_f32_16x16x32_bf16 v[80:83], v[172:175], v[152:155], v[80:83]
  ds_read_b64_tr_b16 v[224:225], v6 offset:10304
  v_add_u32 v4, s28, v4
  v_mfma_f32_16x16x32_bf16 v[84:87], v[172:175], v[156:159], v[84:87]
  ds_read_b64_tr_b16 v[226:227], v6 offset:11584
  v_add_u32 v8, s28, v8
  v_mfma_f32_16x16x32_bf16 v[88:91], v[172:175], v[160:163], v[88:91]
  ds_read_b64_tr_b16 v[228:229], v7 offset:10336
  s_add_u32 s48, s48, 1
  v_mfma_f32_16x16x32_bf16 v[92:95], v[172:175], v[164:167], v[92:95]
  ds_read_b64_tr_b16 v[230:231], v7 offset:11616
  s_cmp_eq_u32 s48, 3
  v_mfma_f32_16x16x32_bf16 v[96:99], v[176:179], v[152:155], v[96:99]
  ds_read_b64_tr_b16 v[232:233], v6 offset:10368
  s_cselect_b32 s51, s50, s49
  v_mfma_f32_16x16x32_bf16 v[100:103], v[176:179], v[156:159], v[100:103]
  ds_read_b64_tr_b16 v[234:235], v6 offset:11648
  s_cselect_b32 s48, 0, s48
  v_mfma_f32_16x16x32_bf16 v[104:107], v[176:179], v[160:163], v[104:107]
  ds_read_b64_tr_b16 v[240:241], v10 offset:1280
  v_add_u32 v6, s28, v6
  v_mfma_f32_16x16x32_bf16 v[108:111], v[176:179], v[164:167], v[108:111]
  ds_read_b64_tr_b16 v[242:243], v10 offset:1440
  v_add_u32 v7, s28, v7
  v_mfma_f32_16x16x32_bf16 v[112:115], v[180:183], v[152:155], v[112:115]
  ds_read_b64_tr_b16 v[244:245], v10 offset:1312
  v_mfma_f32_16x16x32_bf16 v[116:119], v[180:183], v[156:159], v[116:119]
  ds_read_b64_tr_b16 v[246:247], v10 offset:1472
  v_mfma_f32_16x16x32_bf16 v[120:123], v[180:183], v[160:163], v[120:123]
  ds_read_b128 v[200:203], v5 offset:0
  v_add_u32 v10, s51, v10
  v_mfma_f32_16x16x32_bf16 v[124:127], v[180:183], v[164:167], v[124:127]
  ds_read_b128 v[204:207], v5 offset:2048
  v_mfma_f32_16x16x32_bf16 v[128:131], v[184:187], v[152:155], v[128:131]
  ds_read_b128 v[208:211], v5 offset:4096
  v_mfma_f32_16x16x32_bf16 v[132:135], v[184:187], v[156:159], v[132:135]
  ds_read_b128 v[212:215], v5 offset:6144
  v_mfma_f32_16x16x32_bf16 v[136:139], v[184:187], v[160:163], v[136:139]
  ds_read_b128 v[236:239], v9
  v_mfma_f32_16x16x32_bf16 v[140:143], v[184:187], v[164:167], v[140:143]
  v_mfma_f32_16x16x32_bf16 v[144:147], v[192:195], v[188:191], v[144:147]
  s_cmp_eq_u32 s26, 9
  v_mfma_f32_16x16x32_bf16 v[148:151], v[196:199], v[188:191], v[148:151]
  s_waitcnt lgkmcnt(0)
  s_cbranch_scc1 L_k1_cons_A_last
  s_barrier
  s_nop 0
  v_mfma_f32_16x16x32_bf16 v[64:67], v[216:219], v[200:203], v[64:67]
  ds_read_b128 v[152:155], v4 offset:0
  v_add_u32 v5, s28, v5
  v_mfma_f32_16x16x32_bf16 v[68:71], v[216:219], v[204:207], v[68:71]
  ds_read_b128 v[156:159], v4 offset:2048
  v_add_u32 v9, s28, v9
  v_mfma_f32_16x16x32_bf16 v[72:75], v[216:219], v[208:211], v[72:75]
  ds_read_b128 v[160:163], v4 offset:4096
  s_add_u32 s26, s26, 1
  v_mfma_f32_16x16x32_bf16 v[76:79], v[216:219], v[212:215], v[76:79]
  ds_read_b128 v[164:167], v4 offset:6144
  v_mfma_f32_16x16x32_bf16 v[80:83], v[220:223], v[200:203], v[80:83]
  ds_read_b128 v[188:191], v8
  v_mfma_f32_16x16x32_bf16 v[84:87], v[220:223], v[204:207], v[84:87]
  ds_read_b64_tr_b16 v[168:169], v6 offset:0
  v_mfma_f32_16x16x32_bf16 v[88:91], v[220:223], v[208:211], v[88:91]
  ds_read_b64_tr_b16 v[170:171], v6 offset:1280
  v_mfma_f32_16x16x32_bf16 v[92:95], v[220:223], v[212:215], v[92:95]
  ds_read_b64_tr_b16 v[172:173], v7 offset:32
  v_mfma_f32_16x16x32_bf16 v[96:99], v[224:227], v[200:203], v[96:99]
  ds_read_b64_tr_b16 v[174:175], v7 offset:1312
  v_mfma_f32_16x16x32_bf16 v[100:103], v[224:227], v[204:207], v[100:103]
  ds_read_b64_tr_b16 v[176:177], v6 offset:64
  v_mfma_f32_16x16x32_bf16 v[104:107], v[224:227], v[208:211], v[104:107]
  ds_read_b64_tr_b16 v[178:179], v6 offset:1344
  v_mfma_f32_16x16x32_bf16 v[108:111], v[224:227], v[212:215], v[108:111]
  ds_read_b64_tr_b16 v[180:181], v7 offset:96
  v_mfma_f32_16x16x32_bf16 v[112:115], v[228:231], v[200:203], v[112:115]
  ds_read_b64_tr_b16 v[182:183], v7 offset:1376
  v_mfma_f32_16x16x32_bf16 v[116:119], v[228:231], v[204:207], v[116:119]
  ds_read_b64_tr_b16 v[184:185], v6 offset:128
  v_mfma_f32_16x16x32_bf16 v[120:123], v[228:231], v[208:211], v[120:123]
  ds_read_b64_tr_b16 v[186:187], v6 offset:1408
  v_mfma_f32_16x16x32_bf16 v[124:127], v[228:231], v[212:215], v[124:127]
  ds_read_b64_tr_b16 v[192:193], v10 offset:0
  v_mfma_f32_16x16x32_bf16 v[128:131], v[232:235], v[200:203], v[128:131]
  ds_read_b64_tr_b16 v[194:195], v10 offset:160
  v_mfma_f32_16x16x32_bf16 v[132:135], v[232:235], v[204:207], v[132:135]
  ds_read_b64_tr_b16 v[196:197], v10 offset:32
  v_mfma_f32_16x16x32_bf16 v[136:139], v[232:235], v[208:211], v[136:139]
  ds_read_b64_tr_b16 v[198:199], v10 offset:192
  v_mfma_f32_16x16x32_bf16 v[140:143], v[232:235], v[212:215], v[140:143]
  v_mfma_f32_16x16x32_bf16 v[144:147], v[240:243], v[236:239], v[144:147]
  v_mfma_f32_16x16x32_bf16 v[148:151], v[244:247], v[236:239], v[148:151]
  s_branch L_k1_cons_A
L_k1_cons_A_last:
  v_mfma_f32_16x16x32_bf16 v[64:67], v[216:219], v[200:203], v[64:67]
  v_mfma_f32_16x16x32_bf16 v[68:71], v[216:219], v[204:207], v[68:71]
  v_mfma_f32_16x16x32_bf16 v[72:75], v[216:219], v[208:211], v[72:75]
  v_mfma_f32_16x16x32_bf16 v[76:79], v[216:219], v[212:215], v[76:79]
  v_mfma_f32_16x16x32_bf16 v[80:83], v[220:223], v[200:203], v[80:83]
  v_mfma_f32_16x16x32_bf16 v[84:87], v[220:223], v[204:207], v[84:87]
  v_mfma_f32_16x16x32_bf16 v[88:91], v[220:223], v[208:211], v[88:91]
  v_mfma_f32_16x16x32_bf16 v[92:95], v[220:223], v[212:215], v[92:95]
  v_mfma_f32_16x16x32_bf16 v[96:99], v[224:227], v[200:203], v[96:99]
  v_mfma_f32_16x16x32_bf16 v[100:103], v[224:227], v[204:207], v[100:103]
  v_mfma_f32_16x16x32_bf16 v[104:107], v[224:227], v[208:211], v[104:107]
  v_mfma_f32_16x16x32_bf16 v[108:111], v[224:227], v[212:215], v[108:111]
  v_mfma_f32_16x16x32_bf16 v[112:115], v[228:231], v[200:203], v[112:115]
  v_mfma_f32_16x16x32_bf16 v[116:119], v[228:231], v[204:207], v[116:119]
  v_mfma_f32_16x16x32_bf16 v[120:123], v[228:231], v[208:211], v[120:123]
  v_mfma_f32_16x16x32_bf16 v[124:127], v[228:231], v[212:215], v[124:127]
  v_mfma_f32_16x16x32_bf16 v[128:131], v[232:235], v[200:203], v[128:131]
  v_mfma_f32_16x16x32_bf16 v[132:135], v[232:235], v[204:207], v[132:135]
  v_mfma_f32_16x16x32_bf16 v[136:139], v[232:235], v[208:211], v[136:139]
  v_mfma_f32_16x16x32_bf16 v[140:143], v[232:235], v[212:215], v[140:143]
  v_mfma_f32_16x16x32_bf16 v[144:147], v[240:243], v[236:239], v[144:147]
  v_mfma_f32_16x16x32_bf16 v[148:151], v[244:247], v[236:239], v[148:151]
  s_nop 7
  v_cvt_pk_bf16_f32 v144, v144, v145
  v_cvt_pk_bf16_f32 v145, v146, v147
  v_cvt_pk_bf16_f32 v148, v148, v149
  v_cvt_pk_bf16_f32 v149, v150, v151
  s_cmp_ge_u32 s25, 2
  s_cbranch_scc1 L_k1_extra_v
  ds_write_b64 v34, v[144:145]
  s_mov_b64 exec, 0xffff
  ds_write_b64 v35, v[148:149]
  s_mov_b64 exec, -1
  s_branch L_k1_epi_qk
L_k1_extra_v:
  ds_write_b16 v34, v144
  ds_write_b16_d16_hi v34, v144 offset:16
  ds_write_b16 v34, v145 offset:32
  ds_write_b16_d16_hi v34, v145 offset:48
  s_mov_b64 exec, 0xffff
  ds_write_b16 v35, v148 offset:288
  ds_write_b16_d16_hi v35, v148 offset:304
  ds_write_b16 v35, v149 offset:128
  ds_write_b16_d16_hi v35, v149 offset:144
  s_mov_b64 exec, -1
L_k1_epi_qk:
  v_mul_f32 v64, s34, v64
  v_mul_f32 v65, s34, v65
  v_mul_f32 v66, s34, v66
  v_mul_f32 v67, s34, v67
  v_cvt_pk_bf16_f32 v64, v64, v65
  v_cvt_pk_bf16_f32 v65, v66, v67
  ds_write_b64 v24, v[64:65] offset:0
  v_mul_f32 v68, s34, v68
  v_mul_f32 v69, s34, v69
  v_mul_f32 v70, s34, v70
  v_mul_f32 v71, s34, v71
  v_cvt_pk_bf16_f32 v68, v68, v69
  v_cvt_pk_bf16_f32 v69, v70, v71
  ds_write_b64 v29, v[68:69] offset:0
  v_mul_f32 v72, s34, v72
  v_mul_f32 v73, s34, v73
  v_mul_f32 v74, s34, v74
  v_mul_f32 v75, s34, v75
  v_cvt_pk_bf16_f32 v72, v72, v73
  v_cvt_pk_bf16_f32 v73, v74, v75
  ds_write_b64 v24, v[72:73] offset:1280
  v_mul_f32 v76, s34, v76
  v_mul_f32 v77, s34, v77
  v_mul_f32 v78, s34, v78
  v_mul_f32 v79, s34, v79
  v_cvt_pk_bf16_f32 v76, v76, v77
  v_cvt_pk_bf16_f32 v77, v78, v79
  ds_write_b64 v29, v[76:77] offset:1280
  v_mul_f32 v80, s34, v80
  v_mul_f32 v81, s34, v81
  v_mul_f32 v82, s34, v82
  v_mul_f32 v83, s34, v83
  v_cvt_pk_bf16_f32 v80, v80, v81
  v_cvt_pk_bf16_f32 v81, v82, v83
  ds_write_b64 v25, v[80:81] offset:0
  v_mul_f32 v84, s34, v84
  v_mul_f32 v85, s34, v85
  v_mul_f32 v86, s34, v86
  v_mul_f32 v87, s34, v87
  v_cvt_pk_bf16_f32 v84, v84, v85
  v_cvt_pk_bf16_f32 v85, v86, v87
  ds_write_b64 v30, v[84:85] offset:0
  v_mul_f32 v88, s34, v88
  v_mul_f32 v89, s34, v89
  v_mul_f32 v90, s34, v90
  v_mul_f32 v91, s34, v91
  v_cvt_pk_bf16_f32 v88, v88, v89
  v_cvt_pk_bf16_f32 v89, v90, v91
  ds_write_b64 v25, v[88:89] offset:1280
  v_mul_f32 v92, s34, v92
  v_mul_f32 v93, s34, v93
  v_mul_f32 v94, s34, v94
  v_mul_f32 v95, s34, v95
  v_cvt_pk_bf16_f32 v92, v92, v93
  v_cvt_pk_bf16_f32 v93, v94, v95
  ds_write_b64 v30, v[92:93] offset:1280
  v_mul_f32 v96, s34, v96
  v_mul_f32 v97, s34, v97
  v_mul_f32 v98, s34, v98
  v_mul_f32 v99, s34, v99
  v_cvt_pk_bf16_f32 v96, v96, v97
  v_cvt_pk_bf16_f32 v97, v98, v99
  ds_write_b64 v26, v[96:97] offset:0
  v_mul_f32 v100, s34, v100
  v_mul_f32 v101, s34, v101
  v_mul_f32 v102, s34, v102
  v_mul_f32 v103, s34, v103
  v_cvt_pk_bf16_f32 v100, v100, v101
  v_cvt_pk_bf16_f32 v101, v102, v103
  ds_write_b64 v31, v[100:101] offset:0
  v_mul_f32 v104, s34, v104
  v_mul_f32 v105, s34, v105
  v_mul_f32 v106, s34, v106
  v_mul_f32 v107, s34, v107
  v_cvt_pk_bf16_f32 v104, v104, v105
  v_cvt_pk_bf16_f32 v105, v106, v107
  ds_write_b64 v26, v[104:105] offset:1280
  v_mul_f32 v108, s34, v108
  v_mul_f32 v109, s34, v109
  v_mul_f32 v110, s34, v110
  v_mul_f32 v111, s34, v111
  v_cvt_pk_bf16_f32 v108, v108, v109
  v_cvt_pk_bf16_f32 v109, v110, v111
  ds_write_b64 v31, v[108:109] offset:1280
  v_mul_f32 v112, s34, v112
  v_mul_f32 v113, s34, v113
  v_mul_f32 v114, s34, v114
  v_mul_f32 v115, s34, v115
  v_cvt_pk_bf16_f32 v112, v112, v113
  v_cvt_pk_bf16_f32 v113, v114, v115
  ds_write_b64 v27, v[112:113] offset:0
  v_mul_f32 v116, s34, v116
  v_mul_f32 v117, s34, v117
  v_mul_f32 v118, s34, v118
  v_mul_f32 v119, s34, v119
  v_cvt_pk_bf16_f32 v116, v116, v117
  v_cvt_pk_bf16_f32 v117, v118, v119
  ds_write_b64 v32, v[116:117] offset:0
  v_mul_f32 v120, s34, v120
  v_mul_f32 v121, s34, v121
  v_mul_f32 v122, s34, v122
  v_mul_f32 v123, s34, v123
  v_cvt_pk_bf16_f32 v120, v120, v121
  v_cvt_pk_bf16_f32 v121, v122, v123
  ds_write_b64 v27, v[120:121] offset:1280
  v_mul_f32 v124, s34, v124
  v_mul_f32 v125, s34, v125
  v_mul_f32 v126, s34, v126
  v_mul_f32 v127, s34, v127
  v_cvt_pk_bf16_f32 v124, v124, v125
  v_cvt_pk_bf16_f32 v125, v126, v127
  ds_write_b64 v32, v[124:125] offset:1280
  v_mul_f32 v128, s34, v128
  v_mul_f32 v129, s34, v129
  v_mul_f32 v130, s34, v130
  v_mul_f32 v131, s34, v131
  v_cvt_pk_bf16_f32 v128, v128, v129
  v_cvt_pk_bf16_f32 v129, v130, v131
  ds_write_b64 v28, v[128:129] offset:0
  v_mul_f32 v132, s34, v132
  v_mul_f32 v133, s34, v133
  v_mul_f32 v134, s34, v134
  v_mul_f32 v135, s34, v135
  v_cvt_pk_bf16_f32 v132, v132, v133
  v_cvt_pk_bf16_f32 v133, v134, v135
  ds_write_b64 v33, v[132:133] offset:0
  v_mul_f32 v136, s34, v136
  v_mul_f32 v137, s34, v137
  v_mul_f32 v138, s34, v138
  v_mul_f32 v139, s34, v139
  v_cvt_pk_bf16_f32 v136, v136, v137
  v_cvt_pk_bf16_f32 v137, v138, v139
  ds_write_b64 v28, v[136:137] offset:1280
  v_mul_f32 v140, s34, v140
  v_mul_f32 v141, s34, v141
  v_mul_f32 v142, s34, v142
  v_mul_f32 v143, s34, v143
  v_cvt_pk_bf16_f32 v140, v140, v141
  v_cvt_pk_bf16_f32 v141, v142, v143
  ds_write_b64 v33, v[140:141] offset:1280
  s_branch L_k1_copy
L_k1_c_V:
  v_and_b32 v12, 15, v1
  s_and_b32 s28, s25, 1
  s_mul_i32 s28, s28, 80
  v_add_u32 v12, s28, v12
  v_lshrrev_b32 v11, 4, v1
  v_mul_u32_u24 v11, 320, v11
  s_mov_b32 s30, 5120
  v_add_u32 v13, 0, v12
  s_movk_i32 s29, 205
  v_mul_lo_u32 v14, v13, s29
  v_lshrrev_b32 v14, 12, v14
  v_mul_u32_u24 v15, 20, v14
  v_sub_u32 v15, v13, v15
  v_mul_lo_u32 v14, v14, s30
  v_mov_b32 v17, 0
  v_cmp_le_u32 vcc, 4, v15
  s_nop 1
  v_cndmask_b32 v17, v17, 10, vcc
  v_cmp_le_u32 vcc, 8, v15
  s_nop 1
  v_cndmask_b32 v17, v17, 2, vcc
  v_cmp_le_u32 vcc, 12, v15
  s_nop 1
  v_cndmask_b32 v17, v17, -8, vcc
  v_cmp_le_u32 vcc, 16, v15
  s_nop 1
  v_cndmask_b32 v17, v17, 2, vcc
  v_cmp_le_u32 vcc, 18, v15
  s_nop 1
  v_cndmask_b32 v17, v17, -10, vcc
  v_add_u32 v16, v15, v17
  v_lshlrev_b32 v16, 4, v16
  v_add3_u32 v24, v14, v16, v11
  v_add_u32 v24, s35, v24
  v_add_u32 v13, 16, v12
  s_movk_i32 s29, 205
  v_mul_lo_u32 v14, v13, s29
  v_lshrrev_b32 v14, 12, v14
  v_mul_u32_u24 v15, 20, v14
  v_sub_u32 v15, v13, v15
  v_mul_lo_u32 v14, v14, s30
  v_mov_b32 v17, 0
  v_cmp_le_u32 vcc, 4, v15
  s_nop 1
  v_cndmask_b32 v17, v17, 10, vcc
  v_cmp_le_u32 vcc, 8, v15
  s_nop 1
  v_cndmask_b32 v17, v17, 2, vcc
  v_cmp_le_u32 vcc, 12, v15
  s_nop 1
  v_cndmask_b32 v17, v17, -8, vcc
  v_cmp_le_u32 vcc, 16, v15
  s_nop 1
  v_cndmask_b32 v17, v17, 2, vcc
  v_cmp_le_u32 vcc, 18, v15
  s_nop 1
  v_cndmask_b32 v17, v17, -10, vcc
  v_add_u32 v16, v15, v17
  v_lshlrev_b32 v16, 4, v16
  v_add3_u32 v25, v14, v16, v11
  v_add_u32 v25, s35, v25
  v_add_u32 v13, 32, v12
  s_movk_i32 s29, 205
  v_mul_lo_u32 v14, v13, s29
  v_lshrrev_b32 v14, 12, v14
  v_mul_u32_u24 v15, 20, v14
  v_sub_u32 v15, v13, v15
  v_mul_lo_u32 v14, v14, s30
  v_mov_b32 v17, 0
  v_cmp_le_u32 vcc, 4, v15
  s_nop 1
  v_cndmask_b32 v17, v17, 10, vcc
  v_cmp_le_u32 vcc, 8, v15
  s_nop 1
  v_cndmask_b32 v17, v17, 2, vcc
  v_cmp_le_u32 vcc, 12, v15
  s_nop 1
  v_cndmask_b32 v17, v17, -8, vcc
  v_cmp_le_u32 vcc, 16, v15
  s_nop 1
  v_cndmask_b32 v17, v17, 2, vcc
  v_cmp_le_u32 vcc, 18, v15
  s_nop 1
  v_cndmask_b32 v17, v17, -10, vcc
  v_add_u32 v16, v15, v17
  v_lshlrev_b32 v16, 4, v16
  v_add3_u32 v26, v14, v16, v11
  v_add_u32 v26, s35, v26
  v_add_u32 v13, 48, v12
  s_movk_i32 s29, 205
  v_mul_lo_u32 v14, v13, s29
  v_lshrrev_b32 v14, 12, v14
  v_mul_u32_u24 v15, 20, v14
  v_sub_u32 v15, v13, v15
  v_mul_lo_u32 v14, v14, s30
  v_mov_b32 v17, 0
  v_cmp_le_u32 vcc, 4, v15
  s_nop 1
  v_cndmask_b32 v17, v17, 10, vcc
  v_cmp_le_u32 vcc, 8, v15
  s_nop 1
  v_cndmask_b32 v17, v17, 2, vcc
  v_cmp_le_u32 vcc, 12, v15
  s_nop 1
  v_cndmask_b32 v17, v17, -8, vcc
  v_cmp_le_u32 vcc, 16, v15
  s_nop 1
  v_cndmask_b32 v17, v17, 2, vcc
  v_cmp_le_u32 vcc, 18, v15
  s_nop 1
  v_cndmask_b32 v17, v17, -10, vcc
  v_add_u32 v16, v15, v17
  v_lshlrev_b32 v16, 4, v16
  v_add3_u32 v27, v14, v16, v11
  v_add_u32 v27, s35, v27
  v_add_u32 v13, 64, v12
  s_movk_i32 s29, 205
  v_mul_lo_u32 v14, v13, s29
  v_lshrrev_b32 v14, 12, v14
  v_mul_u32_u24 v15, 20, v14
  v_sub_u32 v15, v13, v15
  v_mul_lo_u32 v14, v14, s30
  v_mov_b32 v17, 0
  v_cmp_le_u32 vcc, 4, v15
  s_nop 1
  v_cndmask_b32 v17, v17, 10, vcc
  v_cmp_le_u32 vcc, 8, v15
  s_nop 1
  v_cndmask_b32 v17, v17, 2, vcc
  v_cmp_le_u32 vcc, 12, v15
  s_nop 1
  v_cndmask_b32 v17, v17, -8, vcc
  v_cmp_le_u32 vcc, 16, v15
  s_nop 1
  v_cndmask_b32 v17, v17, 2, vcc
  v_cmp_le_u32 vcc, 18, v15
  s_nop 1
  v_cndmask_b32 v17, v17, -10, vcc
  v_add_u32 v16, v15, v17
  v_lshlrev_b32 v16, 4, v16
  v_add3_u32 v28, v14, v16, v11
  v_add_u32 v28, s35, v28
  s_lshl_b32 s27, s21, 2
  s_cmp_eq_u32 s23, 0
  s_cbranch_scc0 L_k1_cs_kvxxx
  s_xor_b32 s28, s20, 1
  s_lshl_b32 s28, s28, 5
  s_lshl_b32 s29, s24, 3
  s_add_u32 s28, s28, s29
  s_mul_i32 s28, s28, 81920
  s_add_u32 s28, s28, 6291456
  s_mov_b32 s30, 81920
  s_mov_b32 s33, 1280
  s_mov_b32 s34, 0
  s_branch L_k1_cs_donexxx
L_k1_cs_kvxxx:
  s_lshl_b32 s29, s24, 3
  s_mul_i32 s28, s29, 163840
  s_add_u32 s28, s28, 0
  s_mov_b32 s30, 163840
  s_mov_b32 s33, 2560
  s_cmp_eq_u32 s23, 2
  s_cselect_b32 s34, 1280, 0
L_k1_cs_donexxx:
  s_mul_i32 s27, s27, s33
  s_add_u32 s27, s27, s34
  s_add_u32 s28, s28, s27
  s_add_u32 s60, s52, s28
  s_addc_u32 s61, s53, 0
  s_and_b32 s61, s61, 0xffff
  s_lshl_b32 s29, s30, 3
  s_sub_u32 s62, s29, s27
  s_mov_b32 s63, 0x20000
  s_lshl_b32 s27, s25, 6
  v_add_u32 v11, s27, v1
  v_lshlrev_b32 v12, 4, v11
  v_add_u32 v41, 36864, v12
  s_movk_i32 s27, 3277
  v_add_u32 v12, 0, v11
  v_mul_lo_u32 v13, v12, s27
  v_lshrrev_b32 v13, 18, v13
  v_mul_u32_u24 v14, 80, v13
  v_sub_u32 v14, v12, v14
  v_lshrrev_b32 v15, 2, v13
  v_mul_lo_u32 v15, v15, s30
  v_and_b32 v13, 3, v13
  v_mul_lo_u32 v13, v13, s33
  v_lshl_add_u32 v14, v14, 4, v15
  v_add_u32 v36, v14, v13
  v_add_u32 v12, 512, v11
  v_mul_lo_u32 v13, v12, s27
  v_lshrrev_b32 v13, 18, v13
  v_mul_u32_u24 v14, 80, v13
  v_sub_u32 v14, v12, v14
  v_lshrrev_b32 v15, 2, v13
  v_mul_lo_u32 v15, v15, s30
  v_and_b32 v13, 3, v13
  v_mul_lo_u32 v13, v13, s33
  v_lshl_add_u32 v14, v14, 4, v15
  v_add_u32 v37, v14, v13
  v_add_u32 v12, 1024, v11
  v_mul_lo_u32 v13, v12, s27
  v_lshrrev_b32 v13, 18, v13
  v_mul_u32_u24 v14, 80, v13
  v_sub_u32 v14, v12, v14
  v_lshrrev_b32 v15, 2, v13
  v_mul_lo_u32 v15, v15, s30
  v_and_b32 v13, 3, v13
  v_mul_lo_u32 v13, v13, s33
  v_lshl_add_u32 v14, v14, 4, v15
  v_add_u32 v38, v14, v13
  v_add_u32 v12, 1536, v11
  v_mul_lo_u32 v13, v12, s27
  v_lshrrev_b32 v13, 18, v13
  v_mul_u32_u24 v14, 80, v13
  v_sub_u32 v14, v12, v14
  v_lshrrev_b32 v15, 2, v13
  v_mul_lo_u32 v15, v15, s30
  v_and_b32 v13, 3, v13
  v_mul_lo_u32 v13, v13, s33
  v_lshl_add_u32 v14, v14, 4, v15
  v_add_u32 v39, v14, v13
  v_add_u32 v12, 2048, v11
  v_mul_lo_u32 v13, v12, s27
  v_lshrrev_b32 v13, 18, v13
  v_mul_u32_u24 v14, 80, v13
  v_sub_u32 v14, v12, v14
  v_lshrrev_b32 v15, 2, v13
  v_mul_lo_u32 v15, v15, s30
  v_and_b32 v13, 3, v13
  v_mul_lo_u32 v13, v13, s33
  v_lshl_add_u32 v14, v14, 4, v15
  v_add_u32 v40, v14, v13
  s_add_u32 s56, s52, 5242880
  s_addc_u32 s57, s53, 0
  s_and_b32 s57, s57, 0xffff
  s_mov_b32 s58, 163840
  s_mov_b32 s59, 0x20000
  s_lshl_b32 s69, s21, 2
  s_add_u32 s69, s69, s22
  s_mul_i32 s69, s69, 2560
  v_lshlrev_b32 v42, 4, v11
  s_barrier
  ds_read_b128 v[152:155], v4 offset:0
  ds_read_b128 v[156:159], v4 offset:2048
  ds_read_b128 v[160:163], v4 offset:4096
  ds_read_b128 v[164:167], v4 offset:6144
  ds_read_b64_tr_b16 v[168:169], v6 offset:0
  ds_read_b64_tr_b16 v[170:171], v6 offset:1280
  ds_read_b64_tr_b16 v[172:173], v7 offset:32
  ds_read_b64_tr_b16 v[174:175], v7 offset:1312
  ds_read_b64_tr_b16 v[176:177], v6 offset:64
  ds_read_b64_tr_b16 v[178:179], v6 offset:1344
  ds_read_b64_tr_b16 v[180:181], v7 offset:96
  ds_read_b64_tr_b16 v[182:183], v7 offset:1376
  ds_read_b64_tr_b16 v[184:185], v6 offset:128
  ds_read_b64_tr_b16 v[186:187], v6 offset:1408
  s_mov_b32 s26, 0
  s_mov_b32 s27, 0
  s_mov_b32 s66, 36864
  s_mov_b32 s67, 4294893568
  s_mov_b32 s48, 0
  s_mov_b32 s49, 5120
  s_mov_b32 s50, 4294957056
.p2align 3
L_k1_cons_V:
  s_waitcnt lgkmcnt(0)
  s_nop 0
  v_mfma_f32_16x16x32_bf16 v[64:67], v[152:155], v[168:171], v[64:67]
  ds_read_b64_tr_b16 v[216:217], v6 offset:10240
  s_add_u32 s27, s27, 1
  v_mfma_f32_16x16x32_bf16 v[68:71], v[156:159], v[168:171], v[68:71]
  ds_read_b64_tr_b16 v[218:219], v6 offset:11520
  s_cmp_eq_u32 s27, 3
  v_mfma_f32_16x16x32_bf16 v[72:75], v[160:163], v[168:171], v[72:75]
  ds_read_b64_tr_b16 v[220:221], v7 offset:10272
  s_cselect_b32 s28, s67, s66
  v_mfma_f32_16x16x32_bf16 v[76:79], v[164:167], v[168:171], v[76:79]
  ds_read_b64_tr_b16 v[222:223], v7 offset:11552
  s_cselect_b32 s27, 0, s27
  v_mfma_f32_16x16x32_bf16 v[80:83], v[152:155], v[172:175], v[80:83]
  ds_read_b64_tr_b16 v[224:225], v6 offset:10304
  v_add_u32 v4, s28, v4
  v_mfma_f32_16x16x32_bf16 v[84:87], v[156:159], v[172:175], v[84:87]
  ds_read_b64_tr_b16 v[226:227], v6 offset:11584
  v_mfma_f32_16x16x32_bf16 v[88:91], v[160:163], v[172:175], v[88:91]
  ds_read_b64_tr_b16 v[228:229], v7 offset:10336
  v_mfma_f32_16x16x32_bf16 v[92:95], v[164:167], v[172:175], v[92:95]
  ds_read_b64_tr_b16 v[230:231], v7 offset:11616
  v_mfma_f32_16x16x32_bf16 v[96:99], v[152:155], v[176:179], v[96:99]
  ds_read_b64_tr_b16 v[232:233], v6 offset:10368
  v_mfma_f32_16x16x32_bf16 v[100:103], v[156:159], v[176:179], v[100:103]
  ds_read_b64_tr_b16 v[234:235], v6 offset:11648
  v_mfma_f32_16x16x32_bf16 v[104:107], v[160:163], v[176:179], v[104:107]
  ds_read_b128 v[200:203], v5 offset:0
  v_add_u32 v6, s28, v6
  v_mfma_f32_16x16x32_bf16 v[108:111], v[164:167], v[176:179], v[108:111]
  ds_read_b128 v[204:207], v5 offset:2048
  v_add_u32 v7, s28, v7
  v_mfma_f32_16x16x32_bf16 v[112:115], v[152:155], v[180:183], v[112:115]
  ds_read_b128 v[208:211], v5 offset:4096
  v_mfma_f32_16x16x32_bf16 v[116:119], v[156:159], v[180:183], v[116:119]
  ds_read_b128 v[212:215], v5 offset:6144
  v_mfma_f32_16x16x32_bf16 v[120:123], v[160:163], v[180:183], v[120:123]
  v_mfma_f32_16x16x32_bf16 v[124:127], v[164:167], v[180:183], v[124:127]
  v_mfma_f32_16x16x32_bf16 v[128:131], v[152:155], v[184:187], v[128:131]
  v_mfma_f32_16x16x32_bf16 v[132:135], v[156:159], v[184:187], v[132:135]
  v_mfma_f32_16x16x32_bf16 v[136:139], v[160:163], v[184:187], v[136:139]
  s_cmp_eq_u32 s26, 9
  v_mfma_f32_16x16x32_bf16 v[140:143], v[164:167], v[184:187], v[140:143]
  s_waitcnt lgkmcnt(0)
  s_cbranch_scc1 L_k1_cons_V_last
  s_barrier
  s_nop 0
  v_mfma_f32_16x16x32_bf16 v[64:67], v[200:203], v[216:219], v[64:67]
  ds_read_b128 v[152:155], v4 offset:0
  v_add_u32 v5, s28, v5
  v_mfma_f32_16x16x32_bf16 v[68:71], v[204:207], v[216:219], v[68:71]
  ds_read_b128 v[156:159], v4 offset:2048
  v_mfma_f32_16x16x32_bf16 v[72:75], v[208:211], v[216:219], v[72:75]
  ds_read_b128 v[160:163], v4 offset:4096
  s_add_u32 s26, s26, 1
  v_mfma_f32_16x16x32_bf16 v[76:79], v[212:215], v[216:219], v[76:79]
  ds_read_b128 v[164:167], v4 offset:6144
  v_mfma_f32_16x16x32_bf16 v[80:83], v[200:203], v[220:223], v[80:83]
  ds_read_b64_tr_b16 v[168:169], v6 offset:0
  v_mfma_f32_16x16x32_bf16 v[84:87], v[204:207], v[220:223], v[84:87]
  ds_read_b64_tr_b16 v[170:171], v6 offset:1280
  v_mfma_f32_16x16x32_bf16 v[88:91], v[208:211], v[220:223], v[88:91]
  ds_read_b64_tr_b16 v[172:173], v7 offset:32
  v_mfma_f32_16x16x32_bf16 v[92:95], v[212:215], v[220:223], v[92:95]
  ds_read_b64_tr_b16 v[174:175], v7 offset:1312
  v_mfma_f32_16x16x32_bf16 v[96:99], v[200:203], v[224:227], v[96:99]
  ds_read_b64_tr_b16 v[176:177], v6 offset:64
  v_mfma_f32_16x16x32_bf16 v[100:103], v[204:207], v[224:227], v[100:103]
  ds_read_b64_tr_b16 v[178:179], v6 offset:1344
  v_mfma_f32_16x16x32_bf16 v[104:107], v[208:211], v[224:227], v[104:107]
  ds_read_b64_tr_b16 v[180:181], v7 offset:96
  v_mfma_f32_16x16x32_bf16 v[108:111], v[212:215], v[224:227], v[108:111]
  ds_read_b64_tr_b16 v[182:183], v7 offset:1376
  v_mfma_f32_16x16x32_bf16 v[112:115], v[200:203], v[228:231], v[112:115]
  ds_read_b64_tr_b16 v[184:185], v6 offset:128
  v_mfma_f32_16x16x32_bf16 v[116:119], v[204:207], v[228:231], v[116:119]
  ds_read_b64_tr_b16 v[186:187], v6 offset:1408
  v_mfma_f32_16x16x32_bf16 v[120:123], v[208:211], v[228:231], v[120:123]
  v_mfma_f32_16x16x32_bf16 v[124:127], v[212:215], v[228:231], v[124:127]
  v_mfma_f32_16x16x32_bf16 v[128:131], v[200:203], v[232:235], v[128:131]
  v_mfma_f32_16x16x32_bf16 v[132:135], v[204:207], v[232:235], v[132:135]
  v_mfma_f32_16x16x32_bf16 v[136:139], v[208:211], v[232:235], v[136:139]
  v_mfma_f32_16x16x32_bf16 v[140:143], v[212:215], v[232:235], v[140:143]
  s_branch L_k1_cons_V
L_k1_cons_V_last:
  v_mfma_f32_16x16x32_bf16 v[64:67], v[200:203], v[216:219], v[64:67]
  v_mfma_f32_16x16x32_bf16 v[68:71], v[204:207], v[216:219], v[68:71]
  v_mfma_f32_16x16x32_bf16 v[72:75], v[208:211], v[216:219], v[72:75]
  v_mfma_f32_16x16x32_bf16 v[76:79], v[212:215], v[216:219], v[76:79]
  v_mfma_f32_16x16x32_bf16 v[80:83], v[200:203], v[220:223], v[80:83]
  v_mfma_f32_16x16x32_bf16 v[84:87], v[204:207], v[220:223], v[84:87]
  v_mfma_f32_16x16x32_bf16 v[88:91], v[208:211], v[220:223], v[88:91]
  v_mfma_f32_16x16x32_bf16 v[92:95], v[212:215], v[220:223], v[92:95]
  v_mfma_f32_16x16x32_bf16 v[96:99], v[200:203], v[224:227], v[96:99]
  v_mfma_f32_16x16x32_bf16 v[100:103], v[204:207], v[224:227], v[100:103]
  v_mfma_f32_16x16x32_bf16 v[104:107], v[208:211], v[224:227], v[104:107]
  v_mfma_f32_16x16x32_bf16 v[108:111], v[212:215], v[224:227], v[108:111]
  v_mfma_f32_16x16x32_bf16 v[112:115], v[200:203], v[228:231], v[112:115]
  v_mfma_f32_16x16x32_bf16 v[116:119], v[204:207], v[228:231], v[116:119]
  v_mfma_f32_16x16x32_bf16 v[120:123], v[208:211], v[228:231], v[120:123]
  v_mfma_f32_16x16x32_bf16 v[124:127], v[212:215], v[228:231], v[124:127]
  v_mfma_f32_16x16x32_bf16 v[128:131], v[200:203], v[232:235], v[128:131]
  v_mfma_f32_16x16x32_bf16 v[132:135], v[204:207], v[232:235], v[132:135]
  v_mfma_f32_16x16x32_bf16 v[136:139], v[208:211], v[232:235], v[136:139]
  v_mfma_f32_16x16x32_bf16 v[140:143], v[212:215], v[232:235], v[140:143]
  s_nop 7
  v_cvt_pk_bf16_f32 v64, v64, v65
  v_cvt_pk_bf16_f32 v65, v66, v67
  v_cvt_pk_bf16_f32 v66, v68, v69
  v_cvt_pk_bf16_f32 v67, v70, v71
  ds_write_b128 v24, v[64:67] offset:0
  v_cvt_pk_bf16_f32 v72, v72, v73
  v_cvt_pk_bf16_f32 v73, v74, v75
  v_cvt_pk_bf16_f32 v74, v76, v77
  v_cvt_pk_bf16_f32 v75, v78, v79
  ds_write_b128 v24, v[72:75] offset:1280
  v_cvt_pk_bf16_f32 v80, v80, v81
  v_cvt_pk_bf16_f32 v81, v82, v83
  v_cvt_pk_bf16_f32 v82, v84, v85
  v_cvt_pk_bf16_f32 v83, v86, v87
  ds_write_b128 v25, v[80:83] offset:0
  v_cvt_pk_bf16_f32 v88, v88, v89
  v_cvt_pk_bf16_f32 v89, v90, v91
  v_cvt_pk_bf16_f32 v90, v92, v93
  v_cvt_pk_bf16_f32 v91, v94, v95
  ds_write_b128 v25, v[88:91] offset:1280
  v_cvt_pk_bf16_f32 v96, v96, v97
  v_cvt_pk_bf16_f32 v97, v98, v99
  v_cvt_pk_bf16_f32 v98, v100, v101
  v_cvt_pk_bf16_f32 v99, v102, v103
  ds_write_b128 v26, v[96:99] offset:0
  v_cvt_pk_bf16_f32 v104, v104, v105
  v_cvt_pk_bf16_f32 v105, v106, v107
  v_cvt_pk_bf16_f32 v106, v108, v109
  v_cvt_pk_bf16_f32 v107, v110, v111
  ds_write_b128 v26, v[104:107] offset:1280
  v_cvt_pk_bf16_f32 v112, v112, v113
  v_cvt_pk_bf16_f32 v113, v114, v115
  v_cvt_pk_bf16_f32 v114, v116, v117
  v_cvt_pk_bf16_f32 v115, v118, v119
  ds_write_b128 v27, v[112:115] offset:0
  v_cvt_pk_bf16_f32 v120, v120, v121
  v_cvt_pk_bf16_f32 v121, v122, v123
  v_cvt_pk_bf16_f32 v122, v124, v125
  v_cvt_pk_bf16_f32 v123, v126, v127
  ds_write_b128 v27, v[120:123] offset:1280
  v_cvt_pk_bf16_f32 v128, v128, v129
  v_cvt_pk_bf16_f32 v129, v130, v131
  v_cvt_pk_bf16_f32 v130, v132, v133
  v_cvt_pk_bf16_f32 v131, v134, v135
  ds_write_b128 v28, v[128:131] offset:0
  v_cvt_pk_bf16_f32 v136, v136, v137
  v_cvt_pk_bf16_f32 v137, v138, v139
  v_cvt_pk_bf16_f32 v138, v140, v141
  v_cvt_pk_bf16_f32 v139, v142, v143
  ds_write_b128 v28, v[136:139] offset:1280
L_k1_copy:
  s_waitcnt lgkmcnt(0)
  s_barrier
  ds_read_b128 v[44:47], v41 offset:0
  ds_read_b128 v[48:51], v41 offset:8192
  ds_read_b128 v[52:55], v41 offset:16384
  ds_read_b128 v[56:59], v41 offset:24576
  ds_read_b128 v[60:63], v41 offset:32768
  s_waitcnt lgkmcnt(4)
  buffer_store_dwordx4 v[44:47], v36, s[60:63], 0 offen nt
  s_waitcnt lgkmcnt(3)
  buffer_store_dwordx4 v[48:51], v37, s[60:63], 0 offen nt
  s_waitcnt lgkmcnt(2)
  buffer_store_dwordx4 v[52:55], v38, s[60:63], 0 offen nt
  s_waitcnt lgkmcnt(1)
  buffer_store_dwordx4 v[56:59], v39, s[60:63], 0 offen nt
  s_waitcnt lgkmcnt(0)
  buffer_store_dwordx4 v[60:63], v40, s[60:63], 0 offen nt
  s_cmp_eq_u32 s20, 1
  s_cbranch_scc0 L_k1_done
  s_cmp_ge_u32 s25, 3
  s_cbranch_scc1 L_k1_done
  ds_read_b128 v[64:67], v41 offset:40960
  v_cmp_gt_u32 vcc, 2560, v42
  s_waitcnt lgkmcnt(0)
  s_and_b64 exec, exec, vcc
  buffer_store_dwordx4 v[64:67], v42, s[56:59], s69 offen nt
  s_mov_b64 exec, -1
L_k1_done:
  s_endpgm
.globl attn_kernel
.p2align 8
.type attn_kernel,@function
attn_kernel:
  s_cmp_ge_u32 s2, 256
  s_cbranch_scc1 L_k2_done
  s_load_dwordx2 s[4:5], s[0:1], 80
  s_load_dwordx2 s[44:45], s[0:1], 32
  s_load_dwordx2 s[46:47], s[0:1], 56
  s_load_dwordx2 s[48:49], s[0:1], 64
  v_lshrrev_b32 v9, 6, v0
  v_and_b32 v1, 63, v0
  v_readfirstlane_b32 s20, v9
  s_and_b32 s26, s2, 7
  s_lshr_b32 s27, s2, 3
  s_lshr_b32 s51, s27, 4
  s_and_b32 s27, s27, 15
  s_lshr_b32 s28, s27, 2
  s_and_b32 s53, s27, 3
  s_lshl_b32 s27, s26, 2
  s_add_u32 s54, s27, s28
  s_and_b32 s50, s26, 3
  s_lshr_b32 s27, s26, 2
  s_lshl_b32 s27, s27, 2
  s_add_u32 s52, s27, s28
  s_cmp_eq_u32 s51, 0
  s_cselect_b32 s29, 32, s54
  s_mul_i32 s29, s29, 163840
  v_lshlrev_b32 v2, 4, v1
  s_cmp_ge_u32 s20, 4
  s_cbranch_scc0 L_k2_compute
  s_sub_u32 s22, s20, 4
  s_lshl_b32 s26, s22, 10
  s_cmp_eq_u32 s22, 3
  s_cbranch_scc0 L_k2_nocpf
  s_getpc_b64 s[30:31]
L_pc_3:
  s_sub_u32 s30, s30, L_pc_3-attn_kernel
  s_subb_u32 s31, s31, 0
  v_lshlrev_b32 v3, 7, v1
  v_min_u32 v3, L_k2_hotend-attn_kernel-4, v3
  global_load_dword v4, v3, s[30:31]
  v_lshlrev_b32 v3, 7, v1
  v_add_u32 v3, 8192, v3
  v_min_u32 v3, L_k2_hotend-attn_kernel-4, v3
  global_load_dword v4, v3, s[30:31]
L_k2_nocpf:
  s_waitcnt lgkmcnt(0)
  s_add_u32 s8, s4, s29
  s_addc_u32 s9, s5, 0
  s_and_b32 s9, s9, 0xffff
  s_mov_b32 s10, 163840
  s_mov_b32 s11, 0x20000
  s_mov_b32 s27, 3
L_k2_ld_0:
  s_mov_b32 m0, s26
  s_sub_u32 s27, s27, 1
  buffer_load_dwordx4 v2, s[8:11], s26 offen lds
  s_add_u32 s26, s26, 4096
  s_cmp_lg_u32 s27, 0
  s_cbranch_scc1 L_k2_ld_0
  s_waitcnt vmcnt(0)
  s_barrier
  s_mov_b32 s27, 2
L_k2_ld_1:
  s_mov_b32 m0, s26
  s_sub_u32 s27, s27, 1
  buffer_load_dwordx4 v2, s[8:11], s26 offen lds
  s_add_u32 s26, s26, 4096
  s_cmp_lg_u32 s27, 0
  s_cbranch_scc1 L_k2_ld_1
  s_cmp_eq_u32 s51, 0
  s_cselect_b32 s30, s44, s46
  s_cselect_b32 s31, s45, s47
  s_mul_i32 s32, s52, 160
  s_add_u32 s56, s30, s32
  s_addc_u32 s57, s31, 0
  s_and_b32 s57, s57, 0xffff
  s_sub_u32 s58, 819200, s32
  s_mov_b32 s59, 0x20000
  s_movk_i32 s30, 6554
  s_movk_i32 s31, 1280
  v_add_u32 v16, 0, v1
  v_mul_lo_u32 v17, v16, s30
  v_lshrrev_b32 v17, 16, v17
  v_mul_u32_u24 v18, 10, v17
  v_sub_u32 v18, v16, v18
  v_lshlrev_b32 v18, 4, v18
  v_lshrrev_b32 v19, 4, v17
  v_bfe_u32 v20, v17, 3, 1
  v_bfe_u32 v21, v17, 2, 1
  v_and_b32 v22, 3, v17
  v_mul_u32_u24 v23, 20, v19
  v_lshl_add_u32 v23, v21, 3, v23
  v_lshl_add_u32 v23, v20, 2, v23
  v_add_u32 v23, v23, v22
  v_mul_lo_u32 v23, v23, s31
  v_add_u32 v24, v23, v18
  v_lshl_add_u32 v23, v19, 1, v21
  v_lshl_add_u32 v23, v23, 1, v20
  v_mul_u32_u24 v23, 20, v23
  v_add3_u32 v23, v23, v22, 16
  v_mul_lo_u32 v23, v23, s31
  v_add_u32 v29, v23, v18
  v_add_u32 v16, 64, v1
  v_mul_lo_u32 v17, v16, s30
  v_lshrrev_b32 v17, 16, v17
  v_mul_u32_u24 v18, 10, v17
  v_sub_u32 v18, v16, v18
  v_lshlrev_b32 v18, 4, v18
  v_lshrrev_b32 v19, 4, v17
  v_bfe_u32 v20, v17, 3, 1
  v_bfe_u32 v21, v17, 2, 1
  v_and_b32 v22, 3, v17
  v_mul_u32_u24 v23, 20, v19
  v_lshl_add_u32 v23, v21, 3, v23
  v_lshl_add_u32 v23, v20, 2, v23
  v_add_u32 v23, v23, v22
  v_mul_lo_u32 v23, v23, s31
  v_add_u32 v25, v23, v18
  v_lshl_add_u32 v23, v19, 1, v21
  v_lshl_add_u32 v23, v23, 1, v20
  v_mul_u32_u24 v23, 20, v23
  v_add3_u32 v23, v23, v22, 16
  v_mul_lo_u32 v23, v23, s31
  v_add_u32 v30, v23, v18
  v_add_u32 v16, 128, v1
  v_mul_lo_u32 v17, v16, s30
  v_lshrrev_b32 v17, 16, v17
  v_mul_u32_u24 v18, 10, v17
  v_sub_u32 v18, v16, v18
  v_lshlrev_b32 v18, 4, v18
  v_lshrrev_b32 v19, 4, v17
  v_bfe_u32 v20, v17, 3, 1
  v_bfe_u32 v21, v17, 2, 1
  v_and_b32 v22, 3, v17
  v_mul_u32_u24 v23, 20, v19
  v_lshl_add_u32 v23, v21, 3, v23
  v_lshl_add_u32 v23, v20, 2, v23
  v_add_u32 v23, v23, v22
  v_mul_lo_u32 v23, v23, s31
  v_add_u32 v26, v23, v18
  v_lshl_add_u32 v23, v19, 1, v21
  v_lshl_add_u32 v23, v23, 1, v20
  v_mul_u32_u24 v23, 20, v23
  v_add3_u32 v23, v23, v22, 16
  v_mul_lo_u32 v23, v23, s31
  v_add_u32 v31, v23, v18
  v_add_u32 v16, 192, v1
  v_mul_lo_u32 v17, v16, s30
  v_lshrrev_b32 v17, 16, v17
  v_mul_u32_u24 v18, 10, v17
  v_sub_u32 v18, v16, v18
  v_lshlrev_b32 v18, 4, v18
  v_lshrrev_b32 v19, 4, v17
  v_bfe_u32 v20, v17, 3, 1
  v_bfe_u32 v21, v17, 2, 1
  v_and_b32 v22, 3, v17
  v_mul_u32_u24 v23, 20, v19
  v_lshl_add_u32 v23, v21, 3, v23
  v_lshl_add_u32 v23, v20, 2, v23
  v_add_u32 v23, v23, v22
  v_mul_lo_u32 v23, v23, s31
  v_add_u32 v27, v23, v18
  v_lshl_add_u32 v23, v19, 1, v21
  v_lshl_add_u32 v23, v23, 1, v20
  v_mul_u32_u24 v23, 20, v23
  v_add3_u32 v23, v23, v22, 16
  v_mul_lo_u32 v23, v23, s31
  v_add_u32 v32, v23, v18
  v_add_u32 v16, 256, v1
  v_mul_lo_u32 v17, v16, s30
  v_lshrrev_b32 v17, 16, v17
  v_mul_u32_u24 v18, 10, v17
  v_sub_u32 v18, v16, v18
  v_lshlrev_b32 v18, 4, v18
  v_lshrrev_b32 v19, 4, v17
  v_bfe_u32 v20, v17, 3, 1
  v_bfe_u32 v21, v17, 2, 1
  v_and_b32 v22, 3, v17
  v_mul_u32_u24 v23, 20, v19
  v_lshl_add_u32 v23, v21, 3, v23
  v_lshl_add_u32 v23, v20, 2, v23
  v_add_u32 v23, v23, v22
  v_mul_lo_u32 v23, v23, s31
  v_add_u32 v28, v23, v18
  v_lshl_add_u32 v23, v19, 1, v21
  v_lshl_add_u32 v23, v23, 1, v20
  v_mul_u32_u24 v23, 20, v23
  v_add3_u32 v23, v23, v22, 16
  v_mul_lo_u32 v23, v23, s31
  v_add_u32 v33, v23, v18
  s_waitcnt vmcnt(0)
  s_barrier
  s_mov_b32 s27, 5
L_k2_ld_2:
  s_mov_b32 m0, s26
  s_sub_u32 s27, s27, 1
  buffer_load_dwordx4 v2, s[8:11], s26 offen lds
  s_add_u32 s26, s26, 4096
  s_cmp_lg_u32 s27, 0
  s_cbranch_scc1 L_k2_ld_2
  s_waitcnt vmcnt(0)
  s_barrier
  s_mov_b32 s27, 10
L_k2_ld_3:
  s_mov_b32 m0, s26
  s_sub_u32 s27, s27, 1
  buffer_load_dwordx4 v2, s[8:11], s26 offen lds
  s_add_u32 s26, s26, 4096
  s_cmp_lg_u32 s27, 0
  s_cbranch_scc1 L_k2_ld_3
  s_waitcnt vmcnt(0)
  s_barrier
  s_mov_b32 s27, 10
L_k2_ld_4:
  s_mov_b32 m0, s26
  s_sub_u32 s27, s27, 1
  buffer_load_dwordx4 v2, s[8:11], s26 offen lds
  s_add_u32 s26, s26, 4096
  s_cmp_lg_u32 s27, 0
  s_cbranch_scc1 L_k2_ld_4
  s_waitcnt vmcnt(0)
  s_barrier
  s_mov_b32 s27, 10
L_k2_ld_5:
  s_mov_b32 m0, s26
  s_sub_u32 s27, s27, 1
  buffer_load_dwordx4 v2, s[8:11], s26 offen lds
  s_add_u32 s26, s26, 4096
  s_cmp_lg_u32 s27, 0
  s_cbranch_scc1 L_k2_ld_5
  s_waitcnt vmcnt(0)
  s_barrier
  s_mul_i32 s26, s22, 5120
  s_mul_i32 s27, s22, 51200
  s_mov_b32 s28, 0
L_k2_wo0:
  s_add_u32 m0, s26, 0
  s_nop 0
  buffer_load_dwordx4 v24, s[56:59], s27 offen lds
  s_add_u32 m0, s26, 1024
  s_nop 0
  buffer_load_dwordx4 v25, s[56:59], s27 offen lds
  s_add_u32 m0, s26, 2048
  s_nop 0
  buffer_load_dwordx4 v26, s[56:59], s27 offen lds
  s_add_u32 m0, s26, 3072
  s_nop 0
  buffer_load_dwordx4 v27, s[56:59], s27 offen lds
  s_add_u32 m0, s26, 4096
  s_nop 0
  buffer_load_dwordx4 v28, s[56:59], s27 offen lds
  s_add_u32 s26, s26, 20480
  s_add_u32 s27, s27, 204800
  s_add_u32 s28, s28, 1
  s_cmp_lt_u32 s28, 4
  s_cbranch_scc1 L_k2_wo0
  s_mul_i32 s27, s22, 204800
  s_add_u32 m0, s26, 0
  s_nop 0
  buffer_load_dwordx4 v29, s[56:59], s27 offen lds
  s_add_u32 m0, s26, 1024
  s_nop 0
  buffer_load_dwordx4 v30, s[56:59], s27 offen lds
  s_add_u32 m0, s26, 2048
  s_nop 0
  buffer_load_dwordx4 v31, s[56:59], s27 offen lds
  s_add_u32 m0, s26, 3072
  s_nop 0
  buffer_load_dwordx4 v32, s[56:59], s27 offen lds
  s_add_u32 m0, s26, 4096
  s_nop 0
  buffer_load_dwordx4 v33, s[56:59], s27 offen lds
  s_waitcnt vmcnt(0)
  s_barrier
  s_endpgm
L_k2_compute:
  s_lshl_b32 s28, s51, 5
  s_add_u32 s28, s28, s54
  s_mul_i32 s28, s28, 81920
  s_lshl_b32 s27, s53, 4
  s_lshl_b32 s30, s20, 2
  s_add_u32 s27, s27, s30
  s_mul_i32 s25, s27, 1280
  s_add_u32 s26, s25, 2560
  v_and_b32 v9, 31, v1
  v_lshlrev_b32 v3, 3, v9
  v_add_u32 v3, 1024, v3
  v_mov_b32 v32, 0
  v_mov_b32 v33, 0
  v_mov_b32 v34, 0
  v_mov_b32 v35, 0
  v_mov_b32 v36, 0
  v_mov_b32 v37, 0
  v_mov_b32 v38, 0
  v_mov_b32 v39, 0
  s_add_u32 s28, s28, 6291456
  s_waitcnt lgkmcnt(0)
  s_add_u32 s12, s4, s28
  s_addc_u32 s13, s5, 0
  s_and_b32 s13, s13, 0xffff
  s_mov_b32 s14, 81920
  s_mov_b32 s15, 0x20000
  buffer_load_dwordx4 v[16:19], v2, s[12:15], s25 offen offset:0
  buffer_load_dwordx4 v[20:23], v2, s[12:15], s25 offen offset:1280
  buffer_load_dwordx4 v[24:27], v2, s[12:15], s26 offen offset:0
  buffer_load_dwordx4 v[28:31], v2, s[12:15], s26 offen offset:1280
  s_mov_b32 exec_hi, 0
  buffer_load_dwordx2 v[32:33], v3, s[12:15], s25 offen offset:0
  buffer_load_dwordx2 v[34:35], v3, s[12:15], s25 offen offset:1280
  buffer_load_dwordx2 v[36:37], v3, s[12:15], s26 offen offset:0
  buffer_load_dwordx2 v[38:39], v3, s[12:15], s26 offen offset:1280
  s_mov_b32 exec_hi, -1
  v_lshrrev_b32 v10, 5, v1
  v_mul_u32_u24 v10, 1280, v10
  v_add_u32 v10, v10, v3
  buffer_load_dwordx2 v[208:209], v10, s[12:15], s25 offen
  buffer_load_dwordx2 v[210:211], v10, s[12:15], s26 offen
  s_mov_b32 exec_hi, -1
  s_add_u32 s28, s28, 6291456
  s_add_u32 s16, s4, s28
  s_addc_u32 s17, s5, 0
  s_and_b32 s17, s17, 0xffff
  s_mov_b32 s18, 81920
  s_mov_b32 s19, 0x20000
  s_add_u32 s8, s4, s29
  s_addc_u32 s9, s5, 0
  s_and_b32 s9, s9, 0xffff
  s_mov_b32 s10, 163840
  s_mov_b32 s11, 0x20000
  v_mov_b32 v5, v2
  v_mov_b32 v6, v3
  v_mov_b32 v10, 0
  v_cmp_le_u32 vcc, 4, v9
  v_lshrrev_b32 v11, 5, v1
  v_mul_u32_u24 v12, 320, v11
  v_cndmask_b32 v10, v10, 6, vcc
  v_cmp_le_u32 vcc, 12, v9
  v_lshl_add_u32 v14, v11, 2, v3
  v_mov_b32 v8, 0xdddd
  v_cndmask_b32 v10, v10, -8, vcc
  v_cmp_le_u32 vcc, 16, v9
  s_mov_b32 s40, 0x0033ffff
  s_mov_b32 s41, 0x0033ffff
  v_cndmask_b32 v10, v10, 2, vcc
  v_cmp_le_u32 vcc, 20, v9
  v_add_u32 v12, 1280, v12
  v_mov_b32 v13, 0x3f803f80
  v_cndmask_b32 v10, v10, -12, vcc
  v_add_u32 v10, v10, v9
  v_lshl_add_u32 v7, v10, 4, v12
  v_and_b32 v10, 27, v9
  v_cmp_eq_u32 vcc, 18, v10
  v_mov_b32 v10, 0
  s_mov_b32 s56, 1
  s_mov_b32 s57, 43
  v_cndmask_b32 v10, v10, v13, vcc
  v_mov_b32 v52, v10
  v_mov_b32 v53, v10
  v_mov_b32 v54, v10
  v_mov_b32 v55, v10
  v_mov_b32 v56, v10
  v_mov_b32 v57, v10
  v_mov_b32 v58, v10
  v_mov_b32 v59, v10
  v_mov_b32 v60, v10
  v_mov_b32 v61, v10
  v_mov_b32 v62, v10
  v_mov_b32 v63, v10
  v_mov_b32 v64, v10
  v_mov_b32 v65, v10
  v_mov_b32 v66, v10
  v_mov_b32 v67, v10
  v_mov_b32 v68, 0
  v_mov_b32 v69, 0
  v_mov_b32 v70, 0
  v_mov_b32 v71, 0
  v_mov_b32 v72, 0
  v_mov_b32 v73, 0
  v_mov_b32 v74, 0
  v_mov_b32 v75, 0
  v_mov_b32 v76, 0
  v_mov_b32 v77, 0
  v_mov_b32 v78, 0
  v_mov_b32 v79, 0
  v_mov_b32 v80, 0
  v_mov_b32 v81, 0
  v_mov_b32 v82, 0
  v_mov_b32 v83, 0
  v_mov_b32 v84, 0
  v_mov_b32 v85, 0
  v_mov_b32 v86, 0
  v_mov_b32 v87, 0
  v_mov_b32 v88, 0
  v_mov_b32 v89, 0
  v_mov_b32 v90, 0
  v_mov_b32 v91, 0
  v_mov_b32 v92, 0
  v_mov_b32 v93, 0
  v_mov_b32 v94, 0
  v_mov_b32 v95, 0
  v_mov_b32 v96, 0
  v_mov_b32 v97, 0
  v_mov_b32 v98, 0
  v_mov_b32 v99, 0
  v_mov_b32 v100, 0
  v_mov_b32 v101, 0
  v_mov_b32 v102, 0
  v_mov_b32 v103, 0
  v_mov_b32 v104, 0
  v_mov_b32 v105, 0
  v_mov_b32 v106, 0
  v_mov_b32 v107, 0
  v_mov_b32 v108, 0
  v_mov_b32 v109, 0
  v_mov_b32 v110, 0
  v_mov_b32 v111, 0
  v_mov_b32 v112, 0
  v_mov_b32 v113, 0
  v_mov_b32 v114, 0
  v_mov_b32 v115, 0
  v_mov_b32 v116, 0
  v_mov_b32 v117, 0
  v_mov_b32 v118, 0
  v_mov_b32 v119, 0
  v_mov_b32 v120, 0
  v_mov_b32 v121, 0
  v_mov_b32 v122, 0
  v_mov_b32 v123, 0
  v_mov_b32 v124, 0
  v_mov_b32 v125, 0
  v_mov_b32 v126, 0
  v_mov_b32 v127, 0
  v_mov_b32 v128, 0
  v_mov_b32 v129, 0
  v_mov_b32 v130, 0
  v_mov_b32 v131, 0
  v_mov_b32 v188, 0
  v_mov_b32 v189, 0
  v_mov_b32 v190, 0
  v_mov_b32 v191, 0
  v_mov_b32 v192, 0
  v_mov_b32 v193, 0
  v_mov_b32 v194, 0
  v_mov_b32 v195, 0
  s_add_u32 s92, s4, 18874368
  s_addc_u32 s93, s5, 0
  s_and_b32 s93, s93, 0xffff
  s_mov_b32 s94, 1024
  s_mov_b32 s95, 0x20000
  s_lshl_b32 s55, s51, 2
  s_add_u32 s55, s55, s53
  s_lshl_b32 s55, s55, 7
  s_mul_i32 s31, s51, 2621440
  s_add_u32 s31, s31, 12582912
  s_add_u32 s60, s4, s31
  s_addc_u32 s61, s5, 0
  s_and_b32 s61, s61, 0xffff
  s_mov_b32 s62, 2621440
  s_mov_b32 s63, 0x20000
  s_lshl_b32 s31, s50, 2
  s_lshl_b32 s32, s53, 4
  s_add_u32 s31, s31, s32
  s_add_u32 s31, s31, s20
  s_mul_i32 s38, s31, 1280
  s_mul_i32 s31, s31, 81920
  s_mul_i32 s32, s51, 1280
  s_add_u32 s31, s31, s32
  s_mul_i32 s32, s52, 160
  s_add_u32 s31, s31, s32
  s_add_u32 s64, s48, s31
  s_addc_u32 s65, s49, 0
  s_and_b32 s65, s65, 0xffff
  s_sub_u32 s66, 5242880, s31
  s_mov_b32 s67, 0x20000
  v_and_b32 v9, 15, v1
  v_lshrrev_b32 v10, 4, v1
  v_lshrrev_b32 v11, 1, v10
  s_mov_b32 s31, 81920
  v_mul_lo_u32 v11, v11, s31
  v_and_b32 v12, 1, v10
  v_lshlrev_b32 v12, 9, v12
  v_lshl_add_u32 v12, v9, 4, v12
  v_add_u32 v196, v11, v12
  v_lshlrev_b32 v11, 1, v10
  v_mul_lo_u32 v11, v11, s31
  v_lshl_add_u32 v11, v9, 3, v11
  v_add_u32 v197, 1024, v11
  v_lshrrev_b32 v11, 1, v10
  v_lshlrev_b32 v11, 4, v11
  v_and_b32 v12, 1, v10
  v_lshl_add_u32 v11, v12, 2, v11
  v_lshrrev_b32 v12, 2, v9
  v_add_u32 v11, v11, v12
  v_mul_u32_u24 v11, 160, v11
  v_and_b32 v12, 3, v9
  v_mul_u32_u24 v12, 40, v12
  v_add_u32 v198, v11, v12
  v_add_u32 v199, 51200, v198
  s_mul_i32 s32, s20, 5120
  s_add_u32 s32, s32, 102400
  v_mul_u32_u24 v11, 160, v9
  v_mul_u32_u24 v12, 40, v10
  v_add3_u32 v205, v11, v12, s32
  v_lshlrev_b32 v11, 4, v1
  v_add_u32 v206, s32, v11
  s_movk_i32 s31, 6554
  s_movk_i32 s32, 2560
  v_add_u32 v11, 0, v1
  v_mul_lo_u32 v12, v11, s31
  v_lshrrev_b32 v12, 16, v12
  v_mul_u32_u24 v13, 10, v12
  v_sub_u32 v13, v11, v13
  v_mul_lo_u32 v12, v12, s32
  v_lshl_add_u32 v200, v13, 4, v12
  v_add_u32 v11, 64, v1
  v_mul_lo_u32 v12, v11, s31
  v_lshrrev_b32 v12, 16, v12
  v_mul_u32_u24 v13, 10, v12
  v_sub_u32 v13, v11, v13
  v_mul_lo_u32 v12, v12, s32
  v_lshl_add_u32 v201, v13, 4, v12
  v_add_u32 v11, 128, v1
  v_mul_lo_u32 v12, v11, s31
  v_lshrrev_b32 v12, 16, v12
  v_mul_u32_u24 v13, 10, v12
  v_sub_u32 v13, v11, v13
  v_mul_lo_u32 v12, v12, s32
  v_lshl_add_u32 v202, v13, 4, v12
  v_add_u32 v11, 192, v1
  v_mul_lo_u32 v12, v11, s31
  v_lshrrev_b32 v12, 16, v12
  v_mul_u32_u24 v13, 10, v12
  v_sub_u32 v13, v11, v13
  v_mul_lo_u32 v12, v12, s32
  v_lshl_add_u32 v203, v13, 4, v12
  v_add_u32 v11, 256, v1
  v_mul_lo_u32 v12, v11, s31
  v_lshrrev_b32 v12, 16, v12
  v_mul_u32_u24 v13, 10, v12
  v_sub_u32 v13, v11, v13
  v_mul_lo_u32 v12, v12, s32
  v_lshl_add_u32 v204, v13, 4, v12
  s_waitcnt vmcnt(0)
  s_barrier
  ds_read_b128 v[40:43], v5
  s_mov_b32 exec_hi, -1
  ds_read_b64 v[48:49], v6
  s_mov_b64 exec, s[40:41]
  ds_read_b128 v[52:55], v7
  ds_read_b128 v[56:59], v7 offset:640
  s_mov_b64 exec, -1
  s_mov_b32 s21, 0
  s_waitcnt lgkmcnt(0)
  v_mfma_f32_32x32x16_bf16 v[132:147], v[40:43], v[16:19], 0
  v_mfma_f32_32x32x8bf16_1k v[132:147], v[48:49], v[32:33], v[132:147]
  v_mfma_f32_32x32x16_bf16 v[148:163], v[40:43], v[20:23], 0
  v_mfma_f32_32x32x8bf16_1k v[148:163], v[48:49], v[34:35], v[148:163]
  s_nop 15
.p2align 6
L_k2_loop:
  v_exp_f32 v132, v132
  v_exp_f32 v133, v133
  v_smfmac_f32_32x32x32_bf16 v[116:131], v[64:67], v[188:195], v8
  ds_read_b128 v[44:47], v5 offset:2560
  ds_read_b64 v[50:51], v6 offset:2560
  v_exp_f32 v134, v134
  v_exp_f32 v135, v135
  v_exp_f32 v136, v136
  v_exp_f32 v137, v137
  v_mfma_f32_32x32x4bf16_1k v[164:195], v[48:49], v[210:211], 0
  v_exp_f32 v138, v138
  v_exp_f32 v139, v139
  v_exp_f32 v140, v140
  v_exp_f32 v141, v141
  v_exp_f32 v142, v142
  v_exp_f32 v143, v143
  v_exp_f32 v144, v144
  v_exp_f32 v145, v145
  v_smfmac_f32_32x32x32_bf16 v[68:83], v[52:55], v[132:139], v8
  s_mov_b64 exec, s[40:41]
  ds_read_b128 v[60:63], v7 offset:2560
  ds_read_b128 v[64:67], v7 offset:3200
  s_mov_b64 exec, -1
  v_exp_f32 v146, v146
  v_exp_f32 v147, v147
  v_exp_f32 v148, v148
  v_exp_f32 v149, v149
  v_smfmac_f32_32x32x32_bf16 v[68:83], v[56:59], v[140:147], v8
  v_exp_f32 v150, v150
  v_exp_f32 v151, v151
  v_exp_f32 v152, v152
  v_exp_f32 v153, v153
  v_mfma_f32_32x32x16_bf16 v[164:179], v[40:43], v[24:27], v[164:179]
  v_exp_f32 v154, v154
  v_exp_f32 v155, v155
  v_exp_f32 v156, v156
  v_exp_f32 v157, v157
  v_smfmac_f32_32x32x32_bf16 v[84:99], v[52:55], v[148:155], v8
  s_waitcnt lgkmcnt(0)
  s_nop 0
  v_exp_f32 v158, v158
  v_exp_f32 v159, v159
  v_exp_f32 v160, v160
  v_exp_f32 v161, v161
  v_mfma_f32_32x32x16_bf16 v[180:195], v[40:43], v[28:31], v[180:195]
  v_exp_f32 v162, v162
  v_exp_f32 v163, v163
  v_exp_f32 v164, v164
  v_exp_f32 v165, v165
  v_smfmac_f32_32x32x32_bf16 v[84:99], v[56:59], v[156:163], v8
  v_exp_f32 v166, v166
  v_exp_f32 v167, v167
  v_exp_f32 v168, v168
  v_exp_f32 v169, v169
  v_mfma_f32_32x32x4bf16_1k v[132:163], v[50:51], v[208:209], 0
  v_exp_f32 v170, v170
  v_exp_f32 v171, v171
  v_exp_f32 v172, v172
  v_exp_f32 v173, v173
  v_exp_f32 v174, v174
  v_exp_f32 v175, v175
  v_exp_f32 v176, v176
  v_exp_f32 v177, v177
  v_smfmac_f32_32x32x32_bf16 v[100:115], v[52:55], v[164:171], v8
  v_exp_f32 v178, v178
  v_exp_f32 v179, v179
  v_exp_f32 v180, v180
  v_exp_f32 v181, v181
  v_smfmac_f32_32x32x32_bf16 v[100:115], v[56:59], v[172:179], v8
  v_exp_f32 v182, v182
  v_exp_f32 v183, v183
  v_exp_f32 v184, v184
  v_exp_f32 v185, v185
  v_mfma_f32_32x32x16_bf16 v[132:147], v[44:47], v[16:19], v[132:147]
  v_exp_f32 v186, v186
  v_exp_f32 v187, v187
  v_exp_f32 v188, v188
  v_exp_f32 v189, v189
  v_smfmac_f32_32x32x32_bf16 v[116:131], v[52:55], v[180:187], v8
  v_exp_f32 v190, v190
  v_exp_f32 v191, v191
  v_exp_f32 v192, v192
  v_exp_f32 v193, v193
  v_mfma_f32_32x32x16_bf16 v[148:163], v[44:47], v[20:23], v[148:163]
  v_exp_f32 v194, v194
  v_exp_f32 v195, v195
  v_exp_f32 v132, v132
  v_exp_f32 v133, v133
  v_smfmac_f32_32x32x32_bf16 v[116:131], v[56:59], v[188:195], v8
  ds_read_b128 v[40:43], v5 offset:5120
  ds_read_b64 v[48:49], v6 offset:5120
  v_exp_f32 v134, v134
  v_exp_f32 v135, v135
  v_exp_f32 v136, v136
  v_exp_f32 v137, v137
  v_mfma_f32_32x32x4bf16_1k v[164:195], v[50:51], v[210:211], 0
  v_exp_f32 v138, v138
  v_exp_f32 v139, v139
  v_exp_f32 v140, v140
  v_exp_f32 v141, v141
  v_exp_f32 v142, v142
  v_exp_f32 v143, v143
  v_exp_f32 v144, v144
  v_exp_f32 v145, v145
  v_smfmac_f32_32x32x32_bf16 v[68:83], v[60:63], v[132:139], v8
  s_mov_b64 exec, s[40:41]
  ds_read_b128 v[52:55], v7 offset:5120
  ds_read_b128 v[56:59], v7 offset:5760
  s_mov_b64 exec, -1
  v_exp_f32 v146, v146
  v_exp_f32 v147, v147
  v_exp_f32 v148, v148
  v_exp_f32 v149, v149
  v_smfmac_f32_32x32x32_bf16 v[68:83], v[64:67], v[140:147], v8
  v_exp_f32 v150, v150
  v_exp_f32 v151, v151
  v_exp_f32 v152, v152
  v_exp_f32 v153, v153
  v_mfma_f32_32x32x16_bf16 v[164:179], v[44:47], v[24:27], v[164:179]
  v_exp_f32 v154, v154
  v_exp_f32 v155, v155
  v_exp_f32 v156, v156
  v_exp_f32 v157, v157
  v_smfmac_f32_32x32x32_bf16 v[84:99], v[60:63], v[148:155], v8
  s_waitcnt lgkmcnt(0)
  s_nop 0
  v_exp_f32 v158, v158
  v_exp_f32 v159, v159
  v_exp_f32 v160, v160
  v_exp_f32 v161, v161
  v_mfma_f32_32x32x16_bf16 v[180:195], v[44:47], v[28:31], v[180:195]
  v_exp_f32 v162, v162
  v_exp_f32 v163, v163
  v_exp_f32 v164, v164
  v_exp_f32 v165, v165
  v_smfmac_f32_32x32x32_bf16 v[84:99], v[64:67], v[156:163], v8
  v_exp_f32 v166, v166
  v_exp_f32 v167, v167
  v_exp_f32 v168, v168
  v_exp_f32 v169, v169
  v_mfma_f32_32x32x4bf16_1k v[132:163], v[48:49], v[208:209], 0
  v_exp_f32 v170, v170
  v_exp_f32 v171, v171
  v_exp_f32 v172, v172
  v_exp_f32 v173, v173
  v_exp_f32 v174, v174
  v_exp_f32 v175, v175
  v_exp_f32 v176, v176
  v_exp_f32 v177, v177
  v_smfmac_f32_32x32x32_bf16 v[100:115], v[60:63], v[164:171], v8
  v_exp_f32 v178, v178
  v_exp_f32 v179, v179
  v_exp_f32 v180, v180
  v_exp_f32 v181, v181
  v_smfmac_f32_32x32x32_bf16 v[100:115], v[64:67], v[172:179], v8
  v_exp_f32 v182, v182
  v_exp_f32 v183, v183
  v_exp_f32 v184, v184
  v_exp_f32 v185, v185
  v_mfma_f32_32x32x16_bf16 v[132:147], v[40:43], v[16:19], v[132:147]
  v_exp_f32 v186, v186
  v_exp_f32 v187, v187
  v_exp_f32 v188, v188
  v_exp_f32 v189, v189
  v_smfmac_f32_32x32x32_bf16 v[116:131], v[60:63], v[180:187], v8
  v_exp_f32 v190, v190
  v_exp_f32 v191, v191
  v_exp_f32 v192, v192
  v_exp_f32 v193, v193
  v_mfma_f32_32x32x16_bf16 v[148:163], v[40:43], v[20:23], v[148:163]
  v_exp_f32 v194, v194
  v_exp_f32 v195, v195
  v_exp_f32 v132, v132
  v_exp_f32 v133, v133
  v_smfmac_f32_32x32x32_bf16 v[116:131], v[64:67], v[188:195], v8
  ds_read_b128 v[44:47], v5 offset:7680
  ds_read_b64 v[50:51], v6 offset:7680
  v_exp_f32 v134, v134
  v_exp_f32 v135, v135
  v_exp_f32 v136, v136
  v_exp_f32 v137, v137
  v_mfma_f32_32x32x4bf16_1k v[164:195], v[48:49], v[210:211], 0
  v_exp_f32 v138, v138
  v_exp_f32 v139, v139
  v_exp_f32 v140, v140
  v_exp_f32 v141, v141
  v_exp_f32 v142, v142
  v_exp_f32 v143, v143
  v_exp_f32 v144, v144
  v_exp_f32 v145, v145
  v_smfmac_f32_32x32x32_bf16 v[68:83], v[52:55], v[132:139], v8
  s_mov_b64 exec, s[40:41]
  ds_read_b128 v[60:63], v7 offset:7680
  ds_read_b128 v[64:67], v7 offset:8320
  s_mov_b64 exec, -1
  v_exp_f32 v146, v146
  v_exp_f32 v147, v147
  v_exp_f32 v148, v148
  v_exp_f32 v149, v149
  v_smfmac_f32_32x32x32_bf16 v[68:83], v[56:59], v[140:147], v8
  v_exp_f32 v150, v150
  v_exp_f32 v151, v151
  v_exp_f32 v152, v152
  v_exp_f32 v153, v153
  v_mfma_f32_32x32x16_bf16 v[164:179], v[40:43], v[24:27], v[164:179]
  v_exp_f32 v154, v154
  v_exp_f32 v155, v155
  v_exp_f32 v156, v156
  v_exp_f32 v157, v157
  v_smfmac_f32_32x32x32_bf16 v[84:99], v[52:55], v[148:155], v8
  s_waitcnt lgkmcnt(0)
  s_nop 0
  v_exp_f32 v158, v158
  v_exp_f32 v159, v159
  v_exp_f32 v160, v160
  v_exp_f32 v161, v161
  v_mfma_f32_32x32x16_bf16 v[180:195], v[40:43], v[28:31], v[180:195]
  v_exp_f32 v162, v162
  v_exp_f32 v163, v163
  v_exp_f32 v164, v164
  v_exp_f32 v165, v165
  v_smfmac_f32_32x32x32_bf16 v[84:99], v[56:59], v[156:163], v8
  v_exp_f32 v166, v166
  v_exp_f32 v167, v167
  v_exp_f32 v168, v168
  v_exp_f32 v169, v169
  v_mfma_f32_32x32x4bf16_1k v[132:163], v[50:51], v[208:209], 0
  v_exp_f32 v170, v170
  v_exp_f32 v171, v171
  v_exp_f32 v172, v172
  v_exp_f32 v173, v173
  v_exp_f32 v174, v174
  v_exp_f32 v175, v175
  v_exp_f32 v176, v176
  v_exp_f32 v177, v177
  v_smfmac_f32_32x32x32_bf16 v[100:115], v[52:55], v[164:171], v8
  v_exp_f32 v178, v178
  v_exp_f32 v179, v179
  v_exp_f32 v180, v180
  v_exp_f32 v181, v181
  v_smfmac_f32_32x32x32_bf16 v[100:115], v[56:59], v[172:179], v8
  v_exp_f32 v182, v182
  v_exp_f32 v183, v183
  v_exp_f32 v184, v184
  v_exp_f32 v185, v185
  v_mfma_f32_32x32x16_bf16 v[132:147], v[44:47], v[16:19], v[132:147]
  v_exp_f32 v186, v186
  v_exp_f32 v187, v187
  v_exp_f32 v188, v188
  v_exp_f32 v189, v189
  v_smfmac_f32_32x32x32_bf16 v[116:131], v[52:55], v[180:187], v8
  s_bitcmp1_b32 s56, s21
  s_cbranch_scc1 L_k2_bar2
L_k2_barback2:
  v_exp_f32 v190, v190
  v_exp_f32 v191, v191
  v_exp_f32 v192, v192
  v_exp_f32 v193, v193
  v_mfma_f32_32x32x16_bf16 v[148:163], v[44:47], v[20:23], v[148:163]
  v_exp_f32 v194, v194
  v_exp_f32 v195, v195
  v_exp_f32 v132, v132
  v_exp_f32 v133, v133
  v_smfmac_f32_32x32x32_bf16 v[116:131], v[56:59], v[188:195], v8
  ds_read_b128 v[40:43], v5 offset:10240
  ds_read_b64 v[48:49], v6 offset:10240
  v_exp_f32 v134, v134
  v_exp_f32 v135, v135
  v_exp_f32 v136, v136
  v_exp_f32 v137, v137
  v_mfma_f32_32x32x4bf16_1k v[164:195], v[50:51], v[210:211], 0
  v_exp_f32 v138, v138
  v_exp_f32 v139, v139
  v_exp_f32 v140, v140
  v_exp_f32 v141, v141
  v_exp_f32 v142, v142
  v_exp_f32 v143, v143
  v_exp_f32 v144, v144
  v_exp_f32 v145, v145
  v_smfmac_f32_32x32x32_bf16 v[68:83], v[60:63], v[132:139], v8
  s_mov_b64 exec, s[40:41]
  ds_read_b128 v[52:55], v7 offset:10240
  ds_read_b128 v[56:59], v7 offset:10880
  s_mov_b64 exec, -1
  v_exp_f32 v146, v146
  v_exp_f32 v147, v147
  v_exp_f32 v148, v148
  v_exp_f32 v149, v149
  v_smfmac_f32_32x32x32_bf16 v[68:83], v[64:67], v[140:147], v8
  v_exp_f32 v150, v150
  v_exp_f32 v151, v151
  v_exp_f32 v152, v152
  v_exp_f32 v153, v153
  v_mfma_f32_32x32x16_bf16 v[164:179], v[44:47], v[24:27], v[164:179]
  v_exp_f32 v154, v154
  v_exp_f32 v155, v155
  v_exp_f32 v156, v156
  v_exp_f32 v157, v157
  v_smfmac_f32_32x32x32_bf16 v[84:99], v[60:63], v[148:155], v8
  s_waitcnt lgkmcnt(0)
  s_nop 0
  v_exp_f32 v158, v158
  v_exp_f32 v159, v159
  v_exp_f32 v160, v160
  v_exp_f32 v161, v161
  v_mfma_f32_32x32x16_bf16 v[180:195], v[44:47], v[28:31], v[180:195]
  v_exp_f32 v162, v162
  v_exp_f32 v163, v163
  v_exp_f32 v164, v164
  v_exp_f32 v165, v165
  v_smfmac_f32_32x32x32_bf16 v[84:99], v[64:67], v[156:163], v8
  v_exp_f32 v166, v166
  v_exp_f32 v167, v167
  v_exp_f32 v168, v168
  v_exp_f32 v169, v169
  v_mfma_f32_32x32x4bf16_1k v[132:163], v[48:49], v[208:209], 0
  v_exp_f32 v170, v170
  v_exp_f32 v171, v171
  v_exp_f32 v172, v172
  v_exp_f32 v173, v173
  v_exp_f32 v174, v174
  v_exp_f32 v175, v175
  v_exp_f32 v176, v176
  v_exp_f32 v177, v177
  v_smfmac_f32_32x32x32_bf16 v[100:115], v[60:63], v[164:171], v8
  v_exp_f32 v178, v178
  v_exp_f32 v179, v179
  v_exp_f32 v180, v180
  v_exp_f32 v181, v181
  v_smfmac_f32_32x32x32_bf16 v[100:115], v[64:67], v[172:179], v8
  v_exp_f32 v182, v182
  v_exp_f32 v183, v183
  v_exp_f32 v184, v184
  v_exp_f32 v185, v185
  v_mfma_f32_32x32x16_bf16 v[132:147], v[40:43], v[16:19], v[132:147]
  v_exp_f32 v186, v186
  v_exp_f32 v187, v187
  v_exp_f32 v188, v188
  v_exp_f32 v189, v189
  v_smfmac_f32_32x32x32_bf16 v[116:131], v[60:63], v[180:187], v8
  v_exp_f32 v190, v190
  v_exp_f32 v191, v191
  v_exp_f32 v192, v192
  v_exp_f32 v193, v193
  v_mfma_f32_32x32x16_bf16 v[148:163], v[40:43], v[20:23], v[148:163]
  v_exp_f32 v194, v194
  v_exp_f32 v195, v195
  v_exp_f32 v132, v132
  v_exp_f32 v133, v133
  v_smfmac_f32_32x32x32_bf16 v[116:131], v[64:67], v[188:195], v8
  ds_read_b128 v[44:47], v5 offset:12800
  ds_read_b64 v[50:51], v6 offset:12800
  v_exp_f32 v134, v134
  v_exp_f32 v135, v135
  v_exp_f32 v136, v136
  v_exp_f32 v137, v137
  v_mfma_f32_32x32x4bf16_1k v[164:195], v[48:49], v[210:211], 0
  v_exp_f32 v138, v138
  v_exp_f32 v139, v139
  v_exp_f32 v140, v140
  v_exp_f32 v141, v141
  v_exp_f32 v142, v142
  v_exp_f32 v143, v143
  v_exp_f32 v144, v144
  v_exp_f32 v145, v145
  v_smfmac_f32_32x32x32_bf16 v[68:83], v[52:55], v[132:139], v8
  s_mov_b64 exec, s[40:41]
  ds_read_b128 v[60:63], v7 offset:12800
  ds_read_b128 v[64:67], v7 offset:13440
  s_mov_b64 exec, -1
  v_exp_f32 v146, v146
  v_exp_f32 v147, v147
  v_exp_f32 v148, v148
  v_exp_f32 v149, v149
  v_smfmac_f32_32x32x32_bf16 v[68:83], v[56:59], v[140:147], v8
  v_exp_f32 v150, v150
  v_exp_f32 v151, v151
  v_exp_f32 v152, v152
  v_exp_f32 v153, v153
  v_mfma_f32_32x32x16_bf16 v[164:179], v[40:43], v[24:27], v[164:179]
  v_exp_f32 v154, v154
  v_exp_f32 v155, v155
  v_exp_f32 v156, v156
  v_exp_f32 v157, v157
  v_smfmac_f32_32x32x32_bf16 v[84:99], v[52:55], v[148:155], v8
  s_waitcnt lgkmcnt(0)
  s_nop 0
  v_exp_f32 v158, v158
  v_exp_f32 v159, v159
  v_exp_f32 v160, v160
  v_exp_f32 v161, v161
  v_mfma_f32_32x32x16_bf16 v[180:195], v[40:43], v[28:31], v[180:195]
  v_exp_f32 v162, v162
  v_exp_f32 v163, v163
  v_exp_f32 v164, v164
  v_exp_f32 v165, v165
  v_smfmac_f32_32x32x32_bf16 v[84:99], v[56:59], v[156:163], v8
  v_exp_f32 v166, v166
  v_exp_f32 v167, v167
  v_exp_f32 v168, v168
  v_exp_f32 v169, v169
  v_mfma_f32_32x32x4bf16_1k v[132:163], v[50:51], v[208:209], 0
  v_exp_f32 v170, v170
  v_exp_f32 v171, v171
  v_exp_f32 v172, v172
  v_exp_f32 v173, v173
  v_exp_f32 v174, v174
  v_exp_f32 v175, v175
  v_exp_f32 v176, v176
  v_exp_f32 v177, v177
  v_smfmac_f32_32x32x32_bf16 v[100:115], v[52:55], v[164:171], v8
  v_exp_f32 v178, v178
  v_exp_f32 v179, v179
  v_exp_f32 v180, v180
  v_exp_f32 v181, v181
  v_smfmac_f32_32x32x32_bf16 v[100:115], v[56:59], v[172:179], v8
  v_exp_f32 v182, v182
  v_exp_f32 v183, v183
  v_exp_f32 v184, v184
  v_exp_f32 v185, v185
  v_mfma_f32_32x32x16_bf16 v[132:147], v[44:47], v[16:19], v[132:147]
  v_exp_f32 v186, v186
  v_exp_f32 v187, v187
  v_exp_f32 v188, v188
  v_exp_f32 v189, v189
  v_smfmac_f32_32x32x32_bf16 v[116:131], v[52:55], v[180:187], v8
  v_exp_f32 v190, v190
  v_exp_f32 v191, v191
  v_exp_f32 v192, v192
  v_exp_f32 v193, v193
  v_mfma_f32_32x32x16_bf16 v[148:163], v[44:47], v[20:23], v[148:163]
  v_exp_f32 v194, v194
  v_exp_f32 v195, v195
  v_exp_f32 v132, v132
  v_exp_f32 v133, v133
  v_smfmac_f32_32x32x32_bf16 v[116:131], v[56:59], v[188:195], v8
  ds_read_b128 v[40:43], v5 offset:15360
  ds_read_b64 v[48:49], v6 offset:15360
  v_exp_f32 v134, v134
  v_exp_f32 v135, v135
  v_exp_f32 v136, v136
  v_exp_f32 v137, v137
  v_mfma_f32_32x32x4bf16_1k v[164:195], v[50:51], v[210:211], 0
  v_exp_f32 v138, v138
  v_exp_f32 v139, v139
  v_exp_f32 v140, v140
  v_exp_f32 v141, v141
  v_exp_f32 v142, v142
  v_exp_f32 v143, v143
  v_exp_f32 v144, v144
  v_exp_f32 v145, v145
  v_smfmac_f32_32x32x32_bf16 v[68:83], v[60:63], v[132:139], v8
  s_mov_b64 exec, s[40:41]
  ds_read_b128 v[52:55], v7 offset:15360
  ds_read_b128 v[56:59], v7 offset:16000
  s_mov_b64 exec, -1
  v_exp_f32 v146, v146
  v_exp_f32 v147, v147
  v_exp_f32 v148, v148
  v_exp_f32 v149, v149
  v_smfmac_f32_32x32x32_bf16 v[68:83], v[64:67], v[140:147], v8
  v_exp_f32 v150, v150
  v_exp_f32 v151, v151
  v_exp_f32 v152, v152
  v_exp_f32 v153, v153
  v_mfma_f32_32x32x16_bf16 v[164:179], v[44:47], v[24:27], v[164:179]
  v_exp_f32 v154, v154
  v_exp_f32 v155, v155
  v_exp_f32 v156, v156
  v_exp_f32 v157, v157
  v_smfmac_f32_32x32x32_bf16 v[84:99], v[60:63], v[148:155], v8
  s_waitcnt lgkmcnt(0)
  s_nop 0
  v_exp_f32 v158, v158
  v_exp_f32 v159, v159
  v_exp_f32 v160, v160
  v_exp_f32 v161, v161
  v_mfma_f32_32x32x16_bf16 v[180:195], v[44:47], v[28:31], v[180:195]
  v_exp_f32 v162, v162
  v_exp_f32 v163, v163
  v_exp_f32 v164, v164
  v_exp_f32 v165, v165
  v_smfmac_f32_32x32x32_bf16 v[84:99], v[64:67], v[156:163], v8
  v_exp_f32 v166, v166
  v_exp_f32 v167, v167
  v_exp_f32 v168, v168
  v_exp_f32 v169, v169
  v_mfma_f32_32x32x4bf16_1k v[132:163], v[48:49], v[208:209], 0
  v_exp_f32 v170, v170
  v_exp_f32 v171, v171
  v_exp_f32 v172, v172
  v_exp_f32 v173, v173
  v_exp_f32 v174, v174
  v_exp_f32 v175, v175
  v_exp_f32 v176, v176
  v_exp_f32 v177, v177
  v_smfmac_f32_32x32x32_bf16 v[100:115], v[60:63], v[164:171], v8
  v_exp_f32 v178, v178
  v_exp_f32 v179, v179
  v_exp_f32 v180, v180
  v_exp_f32 v181, v181
  v_smfmac_f32_32x32x32_bf16 v[100:115], v[64:67], v[172:179], v8
  v_exp_f32 v182, v182
  v_exp_f32 v183, v183
  v_exp_f32 v184, v184
  v_exp_f32 v185, v185
  v_mfma_f32_32x32x16_bf16 v[132:147], v[40:43], v[16:19], v[132:147]
  v_exp_f32 v186, v186
  v_exp_f32 v187, v187
  v_exp_f32 v188, v188
  v_exp_f32 v189, v189
  v_smfmac_f32_32x32x32_bf16 v[116:131], v[60:63], v[180:187], v8
  v_exp_f32 v190, v190
  v_exp_f32 v191, v191
  v_exp_f32 v192, v192
  v_exp_f32 v193, v193
  v_mfma_f32_32x32x16_bf16 v[148:163], v[40:43], v[20:23], v[148:163]
  v_exp_f32 v194, v194
  v_exp_f32 v195, v195
  v_exp_f32 v132, v132
  v_exp_f32 v133, v133
  v_smfmac_f32_32x32x32_bf16 v[116:131], v[64:67], v[188:195], v8
  ds_read_b128 v[44:47], v5 offset:17920
  ds_read_b64 v[50:51], v6 offset:17920
  v_exp_f32 v134, v134
  v_exp_f32 v135, v135
  v_exp_f32 v136, v136
  v_exp_f32 v137, v137
  v_mfma_f32_32x32x4bf16_1k v[164:195], v[48:49], v[210:211], 0
  v_exp_f32 v138, v138
  v_exp_f32 v139, v139
  v_exp_f32 v140, v140
  v_exp_f32 v141, v141
  v_exp_f32 v142, v142
  v_exp_f32 v143, v143
  v_exp_f32 v144, v144
  v_exp_f32 v145, v145
  v_smfmac_f32_32x32x32_bf16 v[68:83], v[52:55], v[132:139], v8
  s_mov_b64 exec, s[40:41]
  ds_read_b128 v[60:63], v7 offset:17920
  ds_read_b128 v[64:67], v7 offset:18560
  s_mov_b64 exec, -1
  v_exp_f32 v146, v146
  v_exp_f32 v147, v147
  v_exp_f32 v148, v148
  v_exp_f32 v149, v149
  v_smfmac_f32_32x32x32_bf16 v[68:83], v[56:59], v[140:147], v8
  v_exp_f32 v150, v150
  v_exp_f32 v151, v151
  v_exp_f32 v152, v152
  v_exp_f32 v153, v153
  v_mfma_f32_32x32x16_bf16 v[164:179], v[40:43], v[24:27], v[164:179]
  v_exp_f32 v154, v154
  v_exp_f32 v155, v155
  v_exp_f32 v156, v156
  v_exp_f32 v157, v157
  v_smfmac_f32_32x32x32_bf16 v[84:99], v[52:55], v[148:155], v8
  s_waitcnt lgkmcnt(0)
  s_nop 0
  v_exp_f32 v158, v158
  v_exp_f32 v159, v159
  v_exp_f32 v160, v160
  v_exp_f32 v161, v161
  v_mfma_f32_32x32x16_bf16 v[180:195], v[40:43], v[28:31], v[180:195]
  v_exp_f32 v162, v162
  v_exp_f32 v163, v163
  v_exp_f32 v164, v164
  v_exp_f32 v165, v165
  v_smfmac_f32_32x32x32_bf16 v[84:99], v[56:59], v[156:163], v8
  v_exp_f32 v166, v166
  v_exp_f32 v167, v167
  v_exp_f32 v168, v168
  v_exp_f32 v169, v169
  v_mfma_f32_32x32x4bf16_1k v[132:163], v[50:51], v[208:209], 0
  v_exp_f32 v170, v170
  v_exp_f32 v171, v171
  v_exp_f32 v172, v172
  v_exp_f32 v173, v173
  v_exp_f32 v174, v174
  v_exp_f32 v175, v175
  v_exp_f32 v176, v176
  v_exp_f32 v177, v177
  v_smfmac_f32_32x32x32_bf16 v[100:115], v[52:55], v[164:171], v8
  v_exp_f32 v178, v178
  v_exp_f32 v179, v179
  v_exp_f32 v180, v180
  v_exp_f32 v181, v181
  v_smfmac_f32_32x32x32_bf16 v[100:115], v[56:59], v[172:179], v8
  v_exp_f32 v182, v182
  v_exp_f32 v183, v183
  v_exp_f32 v184, v184
  v_exp_f32 v185, v185
  v_mfma_f32_32x32x16_bf16 v[132:147], v[44:47], v[16:19], v[132:147]
  v_exp_f32 v186, v186
  v_exp_f32 v187, v187
  v_exp_f32 v188, v188
  v_exp_f32 v189, v189
  v_smfmac_f32_32x32x32_bf16 v[116:131], v[52:55], v[180:187], v8
  s_bitcmp1_b32 s57, s21
  s_cbranch_scc1 L_k2_bar6
L_k2_barback6:
  v_exp_f32 v190, v190
  v_exp_f32 v191, v191
  v_exp_f32 v192, v192
  v_exp_f32 v193, v193
  v_mfma_f32_32x32x16_bf16 v[148:163], v[44:47], v[20:23], v[148:163]
  v_exp_f32 v194, v194
  v_exp_f32 v195, v195
  v_exp_f32 v132, v132
  v_exp_f32 v133, v133
  v_smfmac_f32_32x32x32_bf16 v[116:131], v[56:59], v[188:195], v8
  ds_read_b128 v[40:43], v5 offset:20480
  ds_read_b64 v[48:49], v6 offset:20480
  v_exp_f32 v134, v134
  v_exp_f32 v135, v135
  v_exp_f32 v136, v136
  v_exp_f32 v137, v137
  v_mfma_f32_32x32x4bf16_1k v[164:195], v[50:51], v[210:211], 0
  v_exp_f32 v138, v138
  v_exp_f32 v139, v139
  v_exp_f32 v140, v140
  v_exp_f32 v141, v141
  v_exp_f32 v142, v142
  v_exp_f32 v143, v143
  v_exp_f32 v144, v144
  v_exp_f32 v145, v145
  v_smfmac_f32_32x32x32_bf16 v[68:83], v[60:63], v[132:139], v8
  s_mov_b64 exec, s[40:41]
  ds_read_b128 v[52:55], v7 offset:20480
  ds_read_b128 v[56:59], v7 offset:21120
  s_mov_b64 exec, -1
  v_exp_f32 v146, v146
  v_exp_f32 v147, v147
  v_exp_f32 v148, v148
  v_exp_f32 v149, v149
  v_smfmac_f32_32x32x32_bf16 v[68:83], v[64:67], v[140:147], v8
  v_exp_f32 v150, v150
  v_exp_f32 v151, v151
  v_exp_f32 v152, v152
  v_exp_f32 v153, v153
  v_mfma_f32_32x32x16_bf16 v[164:179], v[44:47], v[24:27], v[164:179]
  v_exp_f32 v154, v154
  v_exp_f32 v155, v155
  v_exp_f32 v156, v156
  v_exp_f32 v157, v157
  v_smfmac_f32_32x32x32_bf16 v[84:99], v[60:63], v[148:155], v8
  s_waitcnt lgkmcnt(0)
  s_nop 0
  v_exp_f32 v158, v158
  v_exp_f32 v159, v159
  v_exp_f32 v160, v160
  v_exp_f32 v161, v161
  v_mfma_f32_32x32x16_bf16 v[180:195], v[44:47], v[28:31], v[180:195]
  v_exp_f32 v162, v162
  v_exp_f32 v163, v163
  v_exp_f32 v164, v164
  v_exp_f32 v165, v165
  v_smfmac_f32_32x32x32_bf16 v[84:99], v[64:67], v[156:163], v8
  v_exp_f32 v166, v166
  v_exp_f32 v167, v167
  v_exp_f32 v168, v168
  v_exp_f32 v169, v169
  v_mfma_f32_32x32x4bf16_1k v[132:163], v[48:49], v[208:209], 0
  v_exp_f32 v170, v170
  v_exp_f32 v171, v171
  v_exp_f32 v172, v172
  v_exp_f32 v173, v173
  v_exp_f32 v174, v174
  v_exp_f32 v175, v175
  v_exp_f32 v176, v176
  v_exp_f32 v177, v177
  v_smfmac_f32_32x32x32_bf16 v[100:115], v[60:63], v[164:171], v8
  v_exp_f32 v178, v178
  v_exp_f32 v179, v179
  v_exp_f32 v180, v180
  v_exp_f32 v181, v181
  v_smfmac_f32_32x32x32_bf16 v[100:115], v[64:67], v[172:179], v8
  s_add_u32 s21, s21, 1
  s_cmp_lt_u32 s21, 8
  v_exp_f32 v182, v182
  v_exp_f32 v183, v183
  v_exp_f32 v184, v184
  v_exp_f32 v185, v185
  v_mfma_f32_32x32x16_bf16 v[132:147], v[40:43], v[16:19], v[132:147]
  v_exp_f32 v186, v186
  v_exp_f32 v187, v187
  v_exp_f32 v188, v188
  v_exp_f32 v189, v189
  v_smfmac_f32_32x32x32_bf16 v[116:131], v[60:63], v[180:187], v8
  v_exp_f32 v190, v190
  v_exp_f32 v191, v191
  v_exp_f32 v192, v192
  v_exp_f32 v193, v193
  v_mfma_f32_32x32x16_bf16 v[148:163], v[40:43], v[20:23], v[148:163]
  v_exp_f32 v194, v194
  v_exp_f32 v195, v195
  v_add_u32 v5, 20480, v5
  v_add_u32 v6, 20480, v6
  v_add_u32 v7, 20480, v7
  s_cbranch_scc1 L_k2_loop
  v_smfmac_f32_32x32x32_bf16 v[116:131], v[64:67], v[188:195], v8
  s_mov_b32 s30, 0x1f800000
  s_mov_b32 s31, 0x5f800000
  s_mov_b32 s32, 0x7e800000
  s_nop 9
  v_max3_f32 v9, abs(v68), abs(v69), abs(v70)
  v_max3_f32 v9, abs(v71), abs(v72), v9
  v_max3_f32 v9, abs(v73), abs(v74), v9
  v_max3_f32 v9, abs(v75), abs(v76), v9
  v_max_f32 v9, abs(v77), v9
  v_cmp_le_f32 s[34:35], s30, v78
  v_cmp_ge_f32 s[36:37], s31, v78
  v_cmp_ge_f32 vcc, s32, v9
  v_rcp_f32 v9, v78
  s_and_b64 s[34:35], s[34:35], s[36:37]
  s_and_b64 s[34:35], s[34:35], vcc
  s_cmp_eq_u64 s[34:35], -1
  s_cbranch_scc0 L_k2_slow0
L_k2_ok0:
  v_mul_f32 v68, v68, v9
  v_mul_f32 v69, v69, v9
  v_mul_f32 v70, v70, v9
  v_mul_f32 v71, v71, v9
  v_mul_f32 v72, v72, v9
  v_mul_f32 v73, v73, v9
  v_mul_f32 v74, v74, v9
  v_mul_f32 v75, v75, v9
  v_mul_f32 v76, v76, v9
  v_mul_f32 v77, v77, v9
  v_cvt_pk_bf16_f32 v68, v68, v69
  v_cvt_pk_bf16_f32 v69, v70, v71
  v_cvt_pk_bf16_f32 v70, v72, v73
  v_cvt_pk_bf16_f32 v71, v74, v75
  v_cvt_pk_bf16_f32 v72, v76, v77
  buffer_store_dwordx4 v[68:71], v2, s[16:19], s25 offen offset:0 sc1
  buffer_store_dword v72, v14, s[16:19], s25 offen offset:0 sc1
  v_max3_f32 v9, abs(v84), abs(v85), abs(v86)
  v_max3_f32 v9, abs(v87), abs(v88), v9
  v_max3_f32 v9, abs(v89), abs(v90), v9
  v_max3_f32 v9, abs(v91), abs(v92), v9
  v_max_f32 v9, abs(v93), v9
  v_cmp_le_f32 s[34:35], s30, v94
  v_cmp_ge_f32 s[36:37], s31, v94
  v_cmp_ge_f32 vcc, s32, v9
  v_rcp_f32 v9, v94
  s_and_b64 s[34:35], s[34:35], s[36:37]
  s_and_b64 s[34:35], s[34:35], vcc
  s_cmp_eq_u64 s[34:35], -1
  s_cbranch_scc0 L_k2_slow1
L_k2_ok1:
  v_mul_f32 v84, v84, v9
  v_mul_f32 v85, v85, v9
  v_mul_f32 v86, v86, v9
  v_mul_f32 v87, v87, v9
  v_mul_f32 v88, v88, v9
  v_mul_f32 v89, v89, v9
  v_mul_f32 v90, v90, v9
  v_mul_f32 v91, v91, v9
  v_mul_f32 v92, v92, v9
  v_mul_f32 v93, v93, v9
  v_cvt_pk_bf16_f32 v84, v84, v85
  v_cvt_pk_bf16_f32 v85, v86, v87
  v_cvt_pk_bf16_f32 v86, v88, v89
  v_cvt_pk_bf16_f32 v87, v90, v91
  v_cvt_pk_bf16_f32 v88, v92, v93
  buffer_store_dwordx4 v[84:87], v2, s[16:19], s25 offen offset:1280 sc1
  buffer_store_dword v88, v14, s[16:19], s25 offen offset:1280 sc1
  v_max3_f32 v9, abs(v100), abs(v101), abs(v102)
  v_max3_f32 v9, abs(v103), abs(v104), v9
  v_max3_f32 v9, abs(v105), abs(v106), v9
  v_max3_f32 v9, abs(v107), abs(v108), v9
  v_max_f32 v9, abs(v109), v9
  v_cmp_le_f32 s[34:35], s30, v110
  v_cmp_ge_f32 s[36:37], s31, v110
  v_cmp_ge_f32 vcc, s32, v9
  v_rcp_f32 v9, v110
  s_and_b64 s[34:35], s[34:35], s[36:37]
  s_and_b64 s[34:35], s[34:35], vcc
  s_cmp_eq_u64 s[34:35], -1
  s_cbranch_scc0 L_k2_slow2
L_k2_ok2:
  v_mul_f32 v100, v100, v9
  v_mul_f32 v101, v101, v9
  v_mul_f32 v102, v102, v9
  v_mul_f32 v103, v103, v9
  v_mul_f32 v104, v104, v9
  v_mul_f32 v105, v105, v9
  v_mul_f32 v106, v106, v9
  v_mul_f32 v107, v107, v9
  v_mul_f32 v108, v108, v9
  v_mul_f32 v109, v109, v9
  v_cvt_pk_bf16_f32 v100, v100, v101
  v_cvt_pk_bf16_f32 v101, v102, v103
  v_cvt_pk_bf16_f32 v102, v104, v105
  v_cvt_pk_bf16_f32 v103, v106, v107
  v_cvt_pk_bf16_f32 v104, v108, v109
  buffer_store_dwordx4 v[100:103], v2, s[16:19], s26 offen offset:0 sc1
  buffer_store_dword v104, v14, s[16:19], s26 offen offset:0 sc1
  v_max3_f32 v9, abs(v116), abs(v117), abs(v118)
  v_max3_f32 v9, abs(v119), abs(v120), v9
  v_max3_f32 v9, abs(v121), abs(v122), v9
  v_max3_f32 v9, abs(v123), abs(v124), v9
  v_max_f32 v9, abs(v125), v9
  v_cmp_le_f32 s[34:35], s30, v126
  v_cmp_ge_f32 s[36:37], s31, v126
  v_cmp_ge_f32 vcc, s32, v9
  v_rcp_f32 v9, v126
  s_and_b64 s[34:35], s[34:35], s[36:37]
  s_and_b64 s[34:35], s[34:35], vcc
  s_cmp_eq_u64 s[34:35], -1
  s_cbranch_scc0 L_k2_slow3
L_k2_ok3:
  v_mul_f32 v116, v116, v9
  v_mul_f32 v117, v117, v9
  v_mul_f32 v118, v118, v9
  v_mul_f32 v119, v119, v9
  v_mul_f32 v120, v120, v9
  v_mul_f32 v121, v121, v9
  v_mul_f32 v122, v122, v9
  v_mul_f32 v123, v123, v9
  v_mul_f32 v124, v124, v9
  v_mul_f32 v125, v125, v9
  v_cvt_pk_bf16_f32 v116, v116, v117
  v_cvt_pk_bf16_f32 v117, v118, v119
  v_cvt_pk_bf16_f32 v118, v120, v121
  v_cvt_pk_bf16_f32 v119, v122, v123
  v_cvt_pk_bf16_f32 v120, v124, v125
  buffer_store_dwordx4 v[116:119], v2, s[16:19], s26 offen offset:1280 sc1
  buffer_store_dword v120, v14, s[16:19], s26 offen offset:1280 sc1
  s_nop 1
  v_mov_b32 v4, v196
  v_mov_b32 v5, v197
  v_mov_b32 v6, v198
  v_mov_b32 v7, v199
  v_mov_b32 v8, v200
  v_mov_b32 v9, v201
  v_mov_b32 v10, v202
  v_mov_b32 v11, v203
  v_mov_b32 v12, v204
  v_mov_b32 v13, v205
  v_mov_b32 v14, v206
  s_waitcnt vmcnt(0)
  s_barrier
  s_cmp_eq_u32 s20, 0
  s_cbranch_scc0 L_k2_polled
  s_lshl_b32 s31, s54, 2
  s_add_u32 s31, s31, s55
  v_mov_b32 v16, s31
  v_mov_b32 v17, 1511506142
  v_lshlrev_b32 v18, 2, v1
  v_add_u32 v18, s55, v18
  s_mov_b64 exec, 1
  buffer_store_dword v17, v16, s[92:95], 0 offen sc1
  s_mov_b32 exec_lo, -1
  s_mov_b32 exec_hi, 0
  s_mov_b32 s31, 0x40000
L_k2_poll:
  buffer_load_dword v19, v18, s[92:95], 0 offen sc1
  s_sub_u32 s31, s31, 1
  s_waitcnt vmcnt(0)
  v_cmp_ne_u32 vcc, v19, v17
  s_nop 3
  s_cmp_eq_u32 s31, 0
  s_cbranch_scc1 L_k2_pollend
  s_cbranch_vccz L_k2_pollend
  s_sleep 1
  s_branch L_k2_poll
L_k2_pollend:
  s_mov_b64 exec, -1
L_k2_polled:
  s_mov_b32 s33, s38
  s_mov_b32 s34, s38
  s_add_u32 s35, s38, 81920
  s_barrier
  buffer_load_dwordx4 v[56:59], v4, s[60:63], s33 offen offset:0 sc1
  buffer_load_dwordx4 v[60:63], v4, s[60:63], s33 offen offset:256 sc1
  s_add_u32 s33, s33, 163840
  buffer_load_dwordx4 v[64:67], v4, s[60:63], s33 offen offset:0 sc1
  buffer_load_dwordx4 v[68:71], v4, s[60:63], s33 offen offset:256 sc1
  s_add_u32 s33, s33, 163840
  buffer_load_dwordx4 v[72:75], v4, s[60:63], s33 offen offset:0 sc1
  buffer_load_dwordx4 v[76:79], v4, s[60:63], s33 offen offset:256 sc1
  s_add_u32 s33, s33, 163840
  buffer_load_dwordx4 v[80:83], v4, s[60:63], s33 offen offset:0 sc1
  buffer_load_dwordx4 v[84:87], v4, s[60:63], s33 offen offset:256 sc1
  s_add_u32 s33, s33, 163840
  buffer_load_dwordx4 v[88:91], v4, s[60:63], s33 offen offset:0 sc1
  buffer_load_dwordx4 v[92:95], v4, s[60:63], s33 offen offset:256 sc1
  s_add_u32 s33, s33, 163840
  buffer_load_dwordx4 v[96:99], v4, s[60:63], s33 offen offset:0 sc1
  buffer_load_dwordx4 v[100:103], v4, s[60:63], s33 offen offset:256 sc1
  s_add_u32 s33, s33, 163840
  ds_read_b64_tr_b16 v[216:217], v6 offset:0
  ds_read_b64_tr_b16 v[218:219], v6 offset:1280
  ds_read_b64_tr_b16 v[220:221], v6 offset:8
  ds_read_b64_tr_b16 v[222:223], v6 offset:1288
  ds_read_b64_tr_b16 v[224:225], v6 offset:16
  ds_read_b64_tr_b16 v[226:227], v6 offset:1296
  ds_read_b64_tr_b16 v[228:229], v6 offset:24
  ds_read_b64_tr_b16 v[230:231], v6 offset:1304
  ds_read_b64_tr_b16 v[232:233], v6 offset:32
  ds_read_b64_tr_b16 v[234:235], v6 offset:1312
  s_waitcnt vmcnt(10) lgkmcnt(0)
  v_mfma_f32_16x16x32_bf16 v[16:19], v[216:219], v[56:59], 0
  ds_read_b64_tr_b16 v[236:237], v6 offset:5120
  v_mfma_f32_16x16x32_bf16 v[20:23], v[216:219], v[60:63], 0
  ds_read_b64_tr_b16 v[238:239], v6 offset:6400
  buffer_load_dwordx4 v[104:107], v4, s[60:63], s33 offen offset:0 sc1
  v_mfma_f32_16x16x32_bf16 v[24:27], v[220:223], v[56:59], 0
  ds_read_b64_tr_b16 v[240:241], v6 offset:5128
  v_mfma_f32_16x16x32_bf16 v[28:31], v[220:223], v[60:63], 0
  ds_read_b64_tr_b16 v[242:243], v6 offset:6408
  buffer_load_dwordx4 v[108:111], v4, s[60:63], s33 offen offset:256 sc1
  v_mfma_f32_16x16x32_bf16 v[32:35], v[224:227], v[56:59], 0
  ds_read_b64_tr_b16 v[244:245], v6 offset:5136
  v_mfma_f32_16x16x32_bf16 v[36:39], v[224:227], v[60:63], 0
  ds_read_b64_tr_b16 v[246:247], v6 offset:6416
  s_add_u32 s33, s33, 163840
  v_mfma_f32_16x16x32_bf16 v[40:43], v[228:231], v[56:59], 0
  ds_read_b64_tr_b16 v[248:249], v6 offset:5144
  v_mfma_f32_16x16x32_bf16 v[44:47], v[228:231], v[60:63], 0
  ds_read_b64_tr_b16 v[250:251], v6 offset:6424
  v_mfma_f32_16x16x32_bf16 v[48:51], v[232:235], v[56:59], 0
  ds_read_b64_tr_b16 v[252:253], v6 offset:5152
  v_mfma_f32_16x16x32_bf16 v[52:55], v[232:235], v[60:63], 0
  ds_read_b64_tr_b16 v[254:255], v6 offset:6432
  s_waitcnt vmcnt(10) lgkmcnt(0)
  v_mfma_f32_16x16x32_bf16 v[16:19], v[236:239], v[64:67], v[16:19]
  ds_read_b64_tr_b16 v[216:217], v6 offset:10240
  v_mfma_f32_16x16x32_bf16 v[20:23], v[236:239], v[68:71], v[20:23]
  ds_read_b64_tr_b16 v[218:219], v6 offset:11520
  buffer_load_dwordx4 v[112:115], v4, s[60:63], s33 offen offset:0 sc1
  v_mfma_f32_16x16x32_bf16 v[24:27], v[240:243], v[64:67], v[24:27]
  ds_read_b64_tr_b16 v[220:221], v6 offset:10248
  v_mfma_f32_16x16x32_bf16 v[28:31], v[240:243], v[68:71], v[28:31]
  ds_read_b64_tr_b16 v[222:223], v6 offset:11528
  buffer_load_dwordx4 v[116:119], v4, s[60:63], s33 offen offset:256 sc1
  v_mfma_f32_16x16x32_bf16 v[32:35], v[244:247], v[64:67], v[32:35]
  ds_read_b64_tr_b16 v[224:225], v6 offset:10256
  v_mfma_f32_16x16x32_bf16 v[36:39], v[244:247], v[68:71], v[36:39]
  ds_read_b64_tr_b16 v[226:227], v6 offset:11536
  s_add_u32 s33, s33, 163840
  v_mfma_f32_16x16x32_bf16 v[40:43], v[248:251], v[64:67], v[40:43]
  ds_read_b64_tr_b16 v[228:229], v6 offset:10264
  v_mfma_f32_16x16x32_bf16 v[44:47], v[248:251], v[68:71], v[44:47]
  ds_read_b64_tr_b16 v[230:231], v6 offset:11544
  v_mfma_f32_16x16x32_bf16 v[48:51], v[252:255], v[64:67], v[48:51]
  ds_read_b64_tr_b16 v[232:233], v6 offset:10272
  v_mfma_f32_16x16x32_bf16 v[52:55], v[252:255], v[68:71], v[52:55]
  ds_read_b64_tr_b16 v[234:235], v6 offset:11552
  s_waitcnt vmcnt(10) lgkmcnt(0)
  v_mfma_f32_16x16x32_bf16 v[16:19], v[216:219], v[72:75], v[16:19]
  ds_read_b64_tr_b16 v[236:237], v6 offset:15360
  v_mfma_f32_16x16x32_bf16 v[20:23], v[216:219], v[76:79], v[20:23]
  ds_read_b64_tr_b16 v[238:239], v6 offset:16640
  buffer_load_dwordx4 v[120:123], v4, s[60:63], s33 offen offset:0 sc1
  v_mfma_f32_16x16x32_bf16 v[24:27], v[220:223], v[72:75], v[24:27]
  ds_read_b64_tr_b16 v[240:241], v6 offset:15368
  v_mfma_f32_16x16x32_bf16 v[28:31], v[220:223], v[76:79], v[28:31]
  ds_read_b64_tr_b16 v[242:243], v6 offset:16648
  buffer_load_dwordx4 v[124:127], v4, s[60:63], s33 offen offset:256 sc1
  v_mfma_f32_16x16x32_bf16 v[32:35], v[224:227], v[72:75], v[32:35]
  ds_read_b64_tr_b16 v[244:245], v6 offset:15376
  v_mfma_f32_16x16x32_bf16 v[36:39], v[224:227], v[76:79], v[36:39]
  ds_read_b64_tr_b16 v[246:247], v6 offset:16656
  s_add_u32 s33, s33, 163840
  v_mfma_f32_16x16x32_bf16 v[40:43], v[228:231], v[72:75], v[40:43]
  ds_read_b64_tr_b16 v[248:249], v6 offset:15384
  v_mfma_f32_16x16x32_bf16 v[44:47], v[228:231], v[76:79], v[44:47]
  ds_read_b64_tr_b16 v[250:251], v6 offset:16664
  v_mfma_f32_16x16x32_bf16 v[48:51], v[232:235], v[72:75], v[48:51]
  ds_read_b64_tr_b16 v[252:253], v6 offset:15392
  v_mfma_f32_16x16x32_bf16 v[52:55], v[232:235], v[76:79], v[52:55]
  ds_read_b64_tr_b16 v[254:255], v6 offset:16672
  s_waitcnt vmcnt(10) lgkmcnt(0)
  v_mfma_f32_16x16x32_bf16 v[16:19], v[236:239], v[80:83], v[16:19]
  ds_read_b64_tr_b16 v[216:217], v6 offset:20480
  v_mfma_f32_16x16x32_bf16 v[20:23], v[236:239], v[84:87], v[20:23]
  ds_read_b64_tr_b16 v[218:219], v6 offset:21760
  buffer_load_dwordx4 v[128:131], v4, s[60:63], s33 offen offset:0 sc1
  v_mfma_f32_16x16x32_bf16 v[24:27], v[240:243], v[80:83], v[24:27]
  ds_read_b64_tr_b16 v[220:221], v6 offset:20488
  v_mfma_f32_16x16x32_bf16 v[28:31], v[240:243], v[84:87], v[28:31]
  ds_read_b64_tr_b16 v[222:223], v6 offset:21768
  buffer_load_dwordx4 v[132:135], v4, s[60:63], s33 offen offset:256 sc1
  v_mfma_f32_16x16x32_bf16 v[32:35], v[244:247], v[80:83], v[32:35]
  ds_read_b64_tr_b16 v[224:225], v6 offset:20496
  v_mfma_f32_16x16x32_bf16 v[36:39], v[244:247], v[84:87], v[36:39]
  ds_read_b64_tr_b16 v[226:227], v6 offset:21776
  s_add_u32 s33, s33, 163840
  v_mfma_f32_16x16x32_bf16 v[40:43], v[248:251], v[80:83], v[40:43]
  ds_read_b64_tr_b16 v[228:229], v6 offset:20504
  v_mfma_f32_16x16x32_bf16 v[44:47], v[248:251], v[84:87], v[44:47]
  ds_read_b64_tr_b16 v[230:231], v6 offset:21784
  v_mfma_f32_16x16x32_bf16 v[48:51], v[252:255], v[80:83], v[48:51]
  ds_read_b64_tr_b16 v[232:233], v6 offset:20512
  v_mfma_f32_16x16x32_bf16 v[52:55], v[252:255], v[84:87], v[52:55]
  ds_read_b64_tr_b16 v[234:235], v6 offset:21792
  s_waitcnt vmcnt(10) lgkmcnt(0)
  v_mfma_f32_16x16x32_bf16 v[16:19], v[216:219], v[88:91], v[16:19]
  ds_read_b64_tr_b16 v[236:237], v6 offset:25600
  v_mfma_f32_16x16x32_bf16 v[20:23], v[216:219], v[92:95], v[20:23]
  ds_read_b64_tr_b16 v[238:239], v6 offset:26880
  buffer_load_dwordx4 v[136:139], v4, s[60:63], s33 offen offset:0 sc1
  v_mfma_f32_16x16x32_bf16 v[24:27], v[220:223], v[88:91], v[24:27]
  ds_read_b64_tr_b16 v[240:241], v6 offset:25608
  v_mfma_f32_16x16x32_bf16 v[28:31], v[220:223], v[92:95], v[28:31]
  ds_read_b64_tr_b16 v[242:243], v6 offset:26888
  buffer_load_dwordx4 v[140:143], v4, s[60:63], s33 offen offset:256 sc1
  v_mfma_f32_16x16x32_bf16 v[32:35], v[224:227], v[88:91], v[32:35]
  ds_read_b64_tr_b16 v[244:245], v6 offset:25616
  v_mfma_f32_16x16x32_bf16 v[36:39], v[224:227], v[92:95], v[36:39]
  ds_read_b64_tr_b16 v[246:247], v6 offset:26896
  s_add_u32 s33, s33, 163840
  v_mfma_f32_16x16x32_bf16 v[40:43], v[228:231], v[88:91], v[40:43]
  ds_read_b64_tr_b16 v[248:249], v6 offset:25624
  v_mfma_f32_16x16x32_bf16 v[44:47], v[228:231], v[92:95], v[44:47]
  ds_read_b64_tr_b16 v[250:251], v6 offset:26904
  v_mfma_f32_16x16x32_bf16 v[48:51], v[232:235], v[88:91], v[48:51]
  ds_read_b64_tr_b16 v[252:253], v6 offset:25632
  v_mfma_f32_16x16x32_bf16 v[52:55], v[232:235], v[92:95], v[52:55]
  ds_read_b64_tr_b16 v[254:255], v6 offset:26912
  s_waitcnt vmcnt(10) lgkmcnt(0)
  v_mfma_f32_16x16x32_bf16 v[16:19], v[236:239], v[96:99], v[16:19]
  ds_read_b64_tr_b16 v[216:217], v6 offset:30720
  v_mfma_f32_16x16x32_bf16 v[20:23], v[236:239], v[100:103], v[20:23]
  ds_read_b64_tr_b16 v[218:219], v6 offset:32000
  buffer_load_dwordx4 v[144:147], v4, s[60:63], s33 offen offset:0 sc1
  v_mfma_f32_16x16x32_bf16 v[24:27], v[240:243], v[96:99], v[24:27]
  ds_read_b64_tr_b16 v[220:221], v6 offset:30728
  v_mfma_f32_16x16x32_bf16 v[28:31], v[240:243], v[100:103], v[28:31]
  ds_read_b64_tr_b16 v[222:223], v6 offset:32008
  buffer_load_dwordx4 v[148:151], v4, s[60:63], s33 offen offset:256 sc1
  v_mfma_f32_16x16x32_bf16 v[32:35], v[244:247], v[96:99], v[32:35]
  ds_read_b64_tr_b16 v[224:225], v6 offset:30736
  v_mfma_f32_16x16x32_bf16 v[36:39], v[244:247], v[100:103], v[36:39]
  ds_read_b64_tr_b16 v[226:227], v6 offset:32016
  s_add_u32 s33, s33, 163840
  v_mfma_f32_16x16x32_bf16 v[40:43], v[248:251], v[96:99], v[40:43]
  ds_read_b64_tr_b16 v[228:229], v6 offset:30744
  v_mfma_f32_16x16x32_bf16 v[44:47], v[248:251], v[100:103], v[44:47]
  ds_read_b64_tr_b16 v[230:231], v6 offset:32024
  v_mfma_f32_16x16x32_bf16 v[48:51], v[252:255], v[96:99], v[48:51]
  ds_read_b64_tr_b16 v[232:233], v6 offset:30752
  v_mfma_f32_16x16x32_bf16 v[52:55], v[252:255], v[100:103], v[52:55]
  ds_read_b64_tr_b16 v[234:235], v6 offset:32032
  s_waitcnt vmcnt(10) lgkmcnt(0)
  v_mfma_f32_16x16x32_bf16 v[16:19], v[216:219], v[104:107], v[16:19]
  ds_read_b64_tr_b16 v[236:237], v6 offset:35840
  v_mfma_f32_16x16x32_bf16 v[20:23], v[216:219], v[108:111], v[20:23]
  ds_read_b64_tr_b16 v[238:239], v6 offset:37120
  buffer_load_dwordx4 v[152:155], v4, s[60:63], s33 offen offset:0 sc1
  v_mfma_f32_16x16x32_bf16 v[24:27], v[220:223], v[104:107], v[24:27]
  ds_read_b64_tr_b16 v[240:241], v6 offset:35848
  v_mfma_f32_16x16x32_bf16 v[28:31], v[220:223], v[108:111], v[28:31]
  ds_read_b64_tr_b16 v[242:243], v6 offset:37128
  buffer_load_dwordx4 v[156:159], v4, s[60:63], s33 offen offset:256 sc1
  v_mfma_f32_16x16x32_bf16 v[32:35], v[224:227], v[104:107], v[32:35]
  ds_read_b64_tr_b16 v[244:245], v6 offset:35856
  v_mfma_f32_16x16x32_bf16 v[36:39], v[224:227], v[108:111], v[36:39]
  ds_read_b64_tr_b16 v[246:247], v6 offset:37136
  s_add_u32 s33, s33, 163840
  v_mfma_f32_16x16x32_bf16 v[40:43], v[228:231], v[104:107], v[40:43]
  ds_read_b64_tr_b16 v[248:249], v6 offset:35864
  v_mfma_f32_16x16x32_bf16 v[44:47], v[228:231], v[108:111], v[44:47]
  ds_read_b64_tr_b16 v[250:251], v6 offset:37144
  v_mfma_f32_16x16x32_bf16 v[48:51], v[232:235], v[104:107], v[48:51]
  ds_read_b64_tr_b16 v[252:253], v6 offset:35872
  v_mfma_f32_16x16x32_bf16 v[52:55], v[232:235], v[108:111], v[52:55]
  ds_read_b64_tr_b16 v[254:255], v6 offset:37152
  s_waitcnt vmcnt(10) lgkmcnt(0)
  v_mfma_f32_16x16x32_bf16 v[16:19], v[236:239], v[112:115], v[16:19]
  ds_read_b64_tr_b16 v[216:217], v6 offset:40960
  v_mfma_f32_16x16x32_bf16 v[20:23], v[236:239], v[116:119], v[20:23]
  ds_read_b64_tr_b16 v[218:219], v6 offset:42240
  buffer_load_dwordx4 v[160:163], v4, s[60:63], s33 offen offset:0 sc1
  v_mfma_f32_16x16x32_bf16 v[24:27], v[240:243], v[112:115], v[24:27]
  ds_read_b64_tr_b16 v[220:221], v6 offset:40968
  v_mfma_f32_16x16x32_bf16 v[28:31], v[240:243], v[116:119], v[28:31]
  ds_read_b64_tr_b16 v[222:223], v6 offset:42248
  buffer_load_dwordx4 v[164:167], v4, s[60:63], s33 offen offset:256 sc1
  v_mfma_f32_16x16x32_bf16 v[32:35], v[244:247], v[112:115], v[32:35]
  ds_read_b64_tr_b16 v[224:225], v6 offset:40976
  v_mfma_f32_16x16x32_bf16 v[36:39], v[244:247], v[116:119], v[36:39]
  ds_read_b64_tr_b16 v[226:227], v6 offset:42256
  s_add_u32 s33, s33, 163840
  v_mfma_f32_16x16x32_bf16 v[40:43], v[248:251], v[112:115], v[40:43]
  ds_read_b64_tr_b16 v[228:229], v6 offset:40984
  v_mfma_f32_16x16x32_bf16 v[44:47], v[248:251], v[116:119], v[44:47]
  ds_read_b64_tr_b16 v[230:231], v6 offset:42264
  v_mfma_f32_16x16x32_bf16 v[48:51], v[252:255], v[112:115], v[48:51]
  ds_read_b64_tr_b16 v[232:233], v6 offset:40992
  v_mfma_f32_16x16x32_bf16 v[52:55], v[252:255], v[116:119], v[52:55]
  ds_read_b64_tr_b16 v[234:235], v6 offset:42272
  s_waitcnt vmcnt(10) lgkmcnt(0)
  v_mfma_f32_16x16x32_bf16 v[16:19], v[216:219], v[120:123], v[16:19]
  ds_read_b64_tr_b16 v[236:237], v6 offset:46080
  v_mfma_f32_16x16x32_bf16 v[20:23], v[216:219], v[124:127], v[20:23]
  ds_read_b64_tr_b16 v[238:239], v6 offset:47360
  buffer_load_dwordx4 v[168:171], v4, s[60:63], s33 offen offset:0 sc1
  v_mfma_f32_16x16x32_bf16 v[24:27], v[220:223], v[120:123], v[24:27]
  ds_read_b64_tr_b16 v[240:241], v6 offset:46088
  v_mfma_f32_16x16x32_bf16 v[28:31], v[220:223], v[124:127], v[28:31]
  ds_read_b64_tr_b16 v[242:243], v6 offset:47368
  buffer_load_dwordx4 v[172:175], v4, s[60:63], s33 offen offset:256 sc1
  v_mfma_f32_16x16x32_bf16 v[32:35], v[224:227], v[120:123], v[32:35]
  ds_read_b64_tr_b16 v[244:245], v6 offset:46096
  v_mfma_f32_16x16x32_bf16 v[36:39], v[224:227], v[124:127], v[36:39]
  ds_read_b64_tr_b16 v[246:247], v6 offset:47376
  s_add_u32 s33, s33, 163840
  v_mfma_f32_16x16x32_bf16 v[40:43], v[228:231], v[120:123], v[40:43]
  ds_read_b64_tr_b16 v[248:249], v6 offset:46104
  v_mfma_f32_16x16x32_bf16 v[44:47], v[228:231], v[124:127], v[44:47]
  ds_read_b64_tr_b16 v[250:251], v6 offset:47384
  v_mfma_f32_16x16x32_bf16 v[48:51], v[232:235], v[120:123], v[48:51]
  ds_read_b64_tr_b16 v[252:253], v6 offset:46112
  v_mfma_f32_16x16x32_bf16 v[52:55], v[232:235], v[124:127], v[52:55]
  ds_read_b64_tr_b16 v[254:255], v6 offset:47392
  s_waitcnt vmcnt(10) lgkmcnt(0)
  v_mfma_f32_16x16x32_bf16 v[16:19], v[236:239], v[128:131], v[16:19]
  ds_read_b64_tr_b16 v[216:217], v7 offset:0
  v_mfma_f32_16x16x32_bf16 v[20:23], v[236:239], v[132:135], v[20:23]
  ds_read_b64_tr_b16 v[218:219], v7 offset:1280
  buffer_load_dwordx4 v[176:179], v4, s[60:63], s33 offen offset:0 sc1
  v_mfma_f32_16x16x32_bf16 v[24:27], v[240:243], v[128:131], v[24:27]
  ds_read_b64_tr_b16 v[220:221], v7 offset:8
  v_mfma_f32_16x16x32_bf16 v[28:31], v[240:243], v[132:135], v[28:31]
  ds_read_b64_tr_b16 v[222:223], v7 offset:1288
  buffer_load_dwordx4 v[180:183], v4, s[60:63], s33 offen offset:256 sc1
  v_mfma_f32_16x16x32_bf16 v[32:35], v[244:247], v[128:131], v[32:35]
  ds_read_b64_tr_b16 v[224:225], v7 offset:16
  v_mfma_f32_16x16x32_bf16 v[36:39], v[244:247], v[132:135], v[36:39]
  ds_read_b64_tr_b16 v[226:227], v7 offset:1296
  s_add_u32 s33, s33, 163840
  v_mfma_f32_16x16x32_bf16 v[40:43], v[248:251], v[128:131], v[40:43]
  ds_read_b64_tr_b16 v[228:229], v7 offset:24
  v_mfma_f32_16x16x32_bf16 v[44:47], v[248:251], v[132:135], v[44:47]
  ds_read_b64_tr_b16 v[230:231], v7 offset:1304
  v_mfma_f32_16x16x32_bf16 v[48:51], v[252:255], v[128:131], v[48:51]
  ds_read_b64_tr_b16 v[232:233], v7 offset:32
  v_mfma_f32_16x16x32_bf16 v[52:55], v[252:255], v[132:135], v[52:55]
  ds_read_b64_tr_b16 v[234:235], v7 offset:1312
  s_waitcnt vmcnt(10) lgkmcnt(0)
  v_mfma_f32_16x16x32_bf16 v[16:19], v[216:219], v[136:139], v[16:19]
  ds_read_b64_tr_b16 v[236:237], v7 offset:5120
  v_mfma_f32_16x16x32_bf16 v[20:23], v[216:219], v[140:143], v[20:23]
  ds_read_b64_tr_b16 v[238:239], v7 offset:6400
  buffer_load_dwordx2 v[184:185], v5, s[60:63], s34 offen offset:0 sc1
  v_mfma_f32_16x16x32_bf16 v[24:27], v[220:223], v[136:139], v[24:27]
  ds_read_b64_tr_b16 v[240:241], v7 offset:5128
  v_mfma_f32_16x16x32_bf16 v[28:31], v[220:223], v[140:143], v[28:31]
  ds_read_b64_tr_b16 v[242:243], v7 offset:6408
  buffer_load_dwordx2 v[186:187], v5, s[60:63], s35 offen offset:0 sc1
  v_mfma_f32_16x16x32_bf16 v[32:35], v[224:227], v[136:139], v[32:35]
  ds_read_b64_tr_b16 v[244:245], v7 offset:5136
  v_mfma_f32_16x16x32_bf16 v[36:39], v[224:227], v[140:143], v[36:39]
  ds_read_b64_tr_b16 v[246:247], v7 offset:6416
  buffer_load_dwordx2 v[188:189], v5, s[60:63], s34 offen offset:128 sc1
  v_mfma_f32_16x16x32_bf16 v[40:43], v[228:231], v[136:139], v[40:43]
  ds_read_b64_tr_b16 v[248:249], v7 offset:5144
  v_mfma_f32_16x16x32_bf16 v[44:47], v[228:231], v[140:143], v[44:47]
  ds_read_b64_tr_b16 v[250:251], v7 offset:6424
  buffer_load_dwordx2 v[190:191], v5, s[60:63], s35 offen offset:128 sc1
  v_mfma_f32_16x16x32_bf16 v[48:51], v[232:235], v[136:139], v[48:51]
  ds_read_b64_tr_b16 v[252:253], v7 offset:5152
  v_mfma_f32_16x16x32_bf16 v[52:55], v[232:235], v[140:143], v[52:55]
  ds_read_b64_tr_b16 v[254:255], v7 offset:6432
  s_add_u32 s34, s34, 655360
  s_add_u32 s35, s35, 655360
  s_waitcnt vmcnt(12) lgkmcnt(0)
  v_mfma_f32_16x16x32_bf16 v[16:19], v[236:239], v[144:147], v[16:19]
  ds_read_b64_tr_b16 v[216:217], v7 offset:10240
  v_mfma_f32_16x16x32_bf16 v[20:23], v[236:239], v[148:151], v[20:23]
  ds_read_b64_tr_b16 v[218:219], v7 offset:11520
  buffer_load_dwordx2 v[192:193], v5, s[60:63], s34 offen offset:0 sc1
  v_mfma_f32_16x16x32_bf16 v[24:27], v[240:243], v[144:147], v[24:27]
  ds_read_b64_tr_b16 v[220:221], v7 offset:10248
  v_mfma_f32_16x16x32_bf16 v[28:31], v[240:243], v[148:151], v[28:31]
  ds_read_b64_tr_b16 v[222:223], v7 offset:11528
  buffer_load_dwordx2 v[194:195], v5, s[60:63], s35 offen offset:0 sc1
  v_mfma_f32_16x16x32_bf16 v[32:35], v[244:247], v[144:147], v[32:35]
  ds_read_b64_tr_b16 v[224:225], v7 offset:10256
  v_mfma_f32_16x16x32_bf16 v[36:39], v[244:247], v[148:151], v[36:39]
  ds_read_b64_tr_b16 v[226:227], v7 offset:11536
  buffer_load_dwordx2 v[196:197], v5, s[60:63], s34 offen offset:128 sc1
  v_mfma_f32_16x16x32_bf16 v[40:43], v[248:251], v[144:147], v[40:43]
  ds_read_b64_tr_b16 v[228:229], v7 offset:10264
  v_mfma_f32_16x16x32_bf16 v[44:47], v[248:251], v[148:151], v[44:47]
  ds_read_b64_tr_b16 v[230:231], v7 offset:11544
  buffer_load_dwordx2 v[198:199], v5, s[60:63], s35 offen offset:128 sc1
  v_mfma_f32_16x16x32_bf16 v[48:51], v[252:255], v[144:147], v[48:51]
  ds_read_b64_tr_b16 v[232:233], v7 offset:10272
  v_mfma_f32_16x16x32_bf16 v[52:55], v[252:255], v[148:151], v[52:55]
  ds_read_b64_tr_b16 v[234:235], v7 offset:11552
  s_add_u32 s34, s34, 655360
  s_add_u32 s35, s35, 655360
  s_waitcnt vmcnt(14) lgkmcnt(0)
  v_mfma_f32_16x16x32_bf16 v[16:19], v[216:219], v[152:155], v[16:19]
  ds_read_b64_tr_b16 v[236:237], v7 offset:15360
  v_mfma_f32_16x16x32_bf16 v[20:23], v[216:219], v[156:159], v[20:23]
  ds_read_b64_tr_b16 v[238:239], v7 offset:16640
  buffer_load_dwordx2 v[200:201], v5, s[60:63], s34 offen offset:0 sc1
  v_mfma_f32_16x16x32_bf16 v[24:27], v[220:223], v[152:155], v[24:27]
  ds_read_b64_tr_b16 v[240:241], v7 offset:15368
  v_mfma_f32_16x16x32_bf16 v[28:31], v[220:223], v[156:159], v[28:31]
  ds_read_b64_tr_b16 v[242:243], v7 offset:16648
  buffer_load_dwordx2 v[202:203], v5, s[60:63], s35 offen offset:0 sc1
  v_mfma_f32_16x16x32_bf16 v[32:35], v[224:227], v[152:155], v[32:35]
  ds_read_b64_tr_b16 v[244:245], v7 offset:15376
  v_mfma_f32_16x16x32_bf16 v[36:39], v[224:227], v[156:159], v[36:39]
  ds_read_b64_tr_b16 v[246:247], v7 offset:16656
  buffer_load_dwordx2 v[204:205], v5, s[60:63], s34 offen offset:128 sc1
  v_mfma_f32_16x16x32_bf16 v[40:43], v[228:231], v[152:155], v[40:43]
  ds_read_b64_tr_b16 v[248:249], v7 offset:15384
  v_mfma_f32_16x16x32_bf16 v[44:47], v[228:231], v[156:159], v[44:47]
  ds_read_b64_tr_b16 v[250:251], v7 offset:16664
  buffer_load_dwordx2 v[206:207], v5, s[60:63], s35 offen offset:128 sc1
  v_mfma_f32_16x16x32_bf16 v[48:51], v[232:235], v[152:155], v[48:51]
  ds_read_b64_tr_b16 v[252:253], v7 offset:15392
  v_mfma_f32_16x16x32_bf16 v[52:55], v[232:235], v[156:159], v[52:55]
  ds_read_b64_tr_b16 v[254:255], v7 offset:16672
  s_add_u32 s34, s34, 655360
  s_add_u32 s35, s35, 655360
  s_waitcnt vmcnt(16) lgkmcnt(0)
  v_mfma_f32_16x16x32_bf16 v[16:19], v[236:239], v[160:163], v[16:19]
  ds_read_b64_tr_b16 v[216:217], v7 offset:20480
  v_mfma_f32_16x16x32_bf16 v[20:23], v[236:239], v[164:167], v[20:23]
  ds_read_b64_tr_b16 v[218:219], v7 offset:21760
  buffer_load_dwordx2 v[208:209], v5, s[60:63], s34 offen offset:0 sc1
  v_mfma_f32_16x16x32_bf16 v[24:27], v[240:243], v[160:163], v[24:27]
  ds_read_b64_tr_b16 v[220:221], v7 offset:20488
  v_mfma_f32_16x16x32_bf16 v[28:31], v[240:243], v[164:167], v[28:31]
  ds_read_b64_tr_b16 v[222:223], v7 offset:21768
  buffer_load_dwordx2 v[210:211], v5, s[60:63], s35 offen offset:0 sc1
  v_mfma_f32_16x16x32_bf16 v[32:35], v[244:247], v[160:163], v[32:35]
  ds_read_b64_tr_b16 v[224:225], v7 offset:20496
  v_mfma_f32_16x16x32_bf16 v[36:39], v[244:247], v[164:167], v[36:39]
  ds_read_b64_tr_b16 v[226:227], v7 offset:21776
  buffer_load_dwordx2 v[212:213], v5, s[60:63], s34 offen offset:128 sc1
  v_mfma_f32_16x16x32_bf16 v[40:43], v[248:251], v[160:163], v[40:43]
  ds_read_b64_tr_b16 v[228:229], v7 offset:20504
  v_mfma_f32_16x16x32_bf16 v[44:47], v[248:251], v[164:167], v[44:47]
  ds_read_b64_tr_b16 v[230:231], v7 offset:21784
  buffer_load_dwordx2 v[214:215], v5, s[60:63], s35 offen offset:128 sc1
  v_mfma_f32_16x16x32_bf16 v[48:51], v[252:255], v[160:163], v[48:51]
  ds_read_b64_tr_b16 v[232:233], v7 offset:20512
  v_mfma_f32_16x16x32_bf16 v[52:55], v[252:255], v[164:167], v[52:55]
  ds_read_b64_tr_b16 v[234:235], v7 offset:21792
  s_add_u32 s34, s34, 655360
  s_add_u32 s35, s35, 655360
  s_waitcnt vmcnt(18) lgkmcnt(0)
  v_mfma_f32_16x16x32_bf16 v[16:19], v[216:219], v[168:171], v[16:19]
  ds_read_b64_tr_b16 v[236:237], v7 offset:25600
  v_mfma_f32_16x16x32_bf16 v[20:23], v[216:219], v[172:175], v[20:23]
  ds_read_b64_tr_b16 v[238:239], v7 offset:26880
  v_mfma_f32_16x16x32_bf16 v[24:27], v[220:223], v[168:171], v[24:27]
  ds_read_b64_tr_b16 v[240:241], v7 offset:25608
  v_mfma_f32_16x16x32_bf16 v[28:31], v[220:223], v[172:175], v[28:31]
  ds_read_b64_tr_b16 v[242:243], v7 offset:26888
  v_mfma_f32_16x16x32_bf16 v[32:35], v[224:227], v[168:171], v[32:35]
  ds_read_b64_tr_b16 v[244:245], v7 offset:25616
  v_mfma_f32_16x16x32_bf16 v[36:39], v[224:227], v[172:175], v[36:39]
  ds_read_b64_tr_b16 v[246:247], v7 offset:26896
  v_mfma_f32_16x16x32_bf16 v[40:43], v[228:231], v[168:171], v[40:43]
  ds_read_b64_tr_b16 v[248:249], v7 offset:25624
  v_mfma_f32_16x16x32_bf16 v[44:47], v[228:231], v[172:175], v[44:47]
  ds_read_b64_tr_b16 v[250:251], v7 offset:26904
  v_mfma_f32_16x16x32_bf16 v[48:51], v[232:235], v[168:171], v[48:51]
  ds_read_b64_tr_b16 v[252:253], v7 offset:25632
  v_mfma_f32_16x16x32_bf16 v[52:55], v[232:235], v[172:175], v[52:55]
  ds_read_b64_tr_b16 v[254:255], v7 offset:26912
  s_waitcnt vmcnt(16) lgkmcnt(0)
  v_mfma_f32_16x16x32_bf16 v[16:19], v[236:239], v[176:179], v[16:19]
  ds_read_b64_tr_b16 v[216:217], v7 offset:30720
  v_mfma_f32_16x16x32_bf16 v[20:23], v[236:239], v[180:183], v[20:23]
  ds_read_b64_tr_b16 v[218:219], v7 offset:32000
  v_mfma_f32_16x16x32_bf16 v[24:27], v[240:243], v[176:179], v[24:27]
  ds_read_b64_tr_b16 v[220:221], v7 offset:30728
  v_mfma_f32_16x16x32_bf16 v[28:31], v[240:243], v[180:183], v[28:31]
  ds_read_b64_tr_b16 v[222:223], v7 offset:32008
  v_mfma_f32_16x16x32_bf16 v[32:35], v[244:247], v[176:179], v[32:35]
  ds_read_b64_tr_b16 v[224:225], v7 offset:30736
  v_mfma_f32_16x16x32_bf16 v[36:39], v[244:247], v[180:183], v[36:39]
  ds_read_b64_tr_b16 v[226:227], v7 offset:32016
  v_mfma_f32_16x16x32_bf16 v[40:43], v[248:251], v[176:179], v[40:43]
  ds_read_b64_tr_b16 v[228:229], v7 offset:30744
  v_mfma_f32_16x16x32_bf16 v[44:47], v[248:251], v[180:183], v[44:47]
  ds_read_b64_tr_b16 v[230:231], v7 offset:32024
  v_mfma_f32_16x16x32_bf16 v[48:51], v[252:255], v[176:179], v[48:51]
  ds_read_b64_tr_b16 v[232:233], v7 offset:30752
  v_mfma_f32_16x16x32_bf16 v[52:55], v[252:255], v[180:183], v[52:55]
  ds_read_b64_tr_b16 v[234:235], v7 offset:32032
  s_waitcnt vmcnt(12) lgkmcnt(0)
  v_mfma_f32_16x16x32_bf16 v[16:19], v[216:219], v[184:187], v[16:19]
  ds_read_b64_tr_b16 v[236:237], v7 offset:35840
  v_mfma_f32_16x16x32_bf16 v[20:23], v[216:219], v[188:191], v[20:23]
  ds_read_b64_tr_b16 v[238:239], v7 offset:37120
  v_mfma_f32_16x16x32_bf16 v[24:27], v[220:223], v[184:187], v[24:27]
  ds_read_b64_tr_b16 v[240:241], v7 offset:35848
  v_mfma_f32_16x16x32_bf16 v[28:31], v[220:223], v[188:191], v[28:31]
  ds_read_b64_tr_b16 v[242:243], v7 offset:37128
  v_mfma_f32_16x16x32_bf16 v[32:35], v[224:227], v[184:187], v[32:35]
  ds_read_b64_tr_b16 v[244:245], v7 offset:35856
  v_mfma_f32_16x16x32_bf16 v[36:39], v[224:227], v[188:191], v[36:39]
  ds_read_b64_tr_b16 v[246:247], v7 offset:37136
  v_mfma_f32_16x16x32_bf16 v[40:43], v[228:231], v[184:187], v[40:43]
  ds_read_b64_tr_b16 v[248:249], v7 offset:35864
  v_mfma_f32_16x16x32_bf16 v[44:47], v[228:231], v[188:191], v[44:47]
  ds_read_b64_tr_b16 v[250:251], v7 offset:37144
  v_mfma_f32_16x16x32_bf16 v[48:51], v[232:235], v[184:187], v[48:51]
  ds_read_b64_tr_b16 v[252:253], v7 offset:35872
  v_mfma_f32_16x16x32_bf16 v[52:55], v[232:235], v[188:191], v[52:55]
  ds_read_b64_tr_b16 v[254:255], v7 offset:37152
  s_waitcnt vmcnt(8) lgkmcnt(0)
  v_mfma_f32_16x16x32_bf16 v[16:19], v[236:239], v[192:195], v[16:19]
  ds_read_b64_tr_b16 v[216:217], v7 offset:40960
  v_mfma_f32_16x16x32_bf16 v[20:23], v[236:239], v[196:199], v[20:23]
  ds_read_b64_tr_b16 v[218:219], v7 offset:42240
  v_mfma_f32_16x16x32_bf16 v[24:27], v[240:243], v[192:195], v[24:27]
  ds_read_b64_tr_b16 v[220:221], v7 offset:40968
  v_mfma_f32_16x16x32_bf16 v[28:31], v[240:243], v[196:199], v[28:31]
  ds_read_b64_tr_b16 v[222:223], v7 offset:42248
  v_mfma_f32_16x16x32_bf16 v[32:35], v[244:247], v[192:195], v[32:35]
  ds_read_b64_tr_b16 v[224:225], v7 offset:40976
  v_mfma_f32_16x16x32_bf16 v[36:39], v[244:247], v[196:199], v[36:39]
  ds_read_b64_tr_b16 v[226:227], v7 offset:42256
  v_mfma_f32_16x16x32_bf16 v[40:43], v[248:251], v[192:195], v[40:43]
  ds_read_b64_tr_b16 v[228:229], v7 offset:40984
  v_mfma_f32_16x16x32_bf16 v[44:47], v[248:251], v[196:199], v[44:47]
  ds_read_b64_tr_b16 v[230:231], v7 offset:42264
  v_mfma_f32_16x16x32_bf16 v[48:51], v[252:255], v[192:195], v[48:51]
  ds_read_b64_tr_b16 v[232:233], v7 offset:40992
  v_mfma_f32_16x16x32_bf16 v[52:55], v[252:255], v[196:199], v[52:55]
  ds_read_b64_tr_b16 v[234:235], v7 offset:42272
  s_waitcnt vmcnt(4) lgkmcnt(0)
  v_mfma_f32_16x16x32_bf16 v[16:19], v[216:219], v[200:203], v[16:19]
  ds_read_b64_tr_b16 v[236:237], v7 offset:46080
  v_mfma_f32_16x16x32_bf16 v[20:23], v[216:219], v[204:207], v[20:23]
  ds_read_b64_tr_b16 v[238:239], v7 offset:47360
  v_mfma_f32_16x16x32_bf16 v[24:27], v[220:223], v[200:203], v[24:27]
  ds_read_b64_tr_b16 v[240:241], v7 offset:46088
  v_mfma_f32_16x16x32_bf16 v[28:31], v[220:223], v[204:207], v[28:31]
  ds_read_b64_tr_b16 v[242:243], v7 offset:47368
  v_mfma_f32_16x16x32_bf16 v[32:35], v[224:227], v[200:203], v[32:35]
  ds_read_b64_tr_b16 v[244:245], v7 offset:46096
  v_mfma_f32_16x16x32_bf16 v[36:39], v[224:227], v[204:207], v[36:39]
  ds_read_b64_tr_b16 v[246:247], v7 offset:47376
  v_mfma_f32_16x16x32_bf16 v[40:43], v[228:231], v[200:203], v[40:43]
  ds_read_b64_tr_b16 v[248:249], v7 offset:46104
  v_mfma_f32_16x16x32_bf16 v[44:47], v[228:231], v[204:207], v[44:47]
  ds_read_b64_tr_b16 v[250:251], v7 offset:47384
  v_mfma_f32_16x16x32_bf16 v[48:51], v[232:235], v[200:203], v[48:51]
  ds_read_b64_tr_b16 v[252:253], v7 offset:46112
  v_mfma_f32_16x16x32_bf16 v[52:55], v[232:235], v[204:207], v[52:55]
  ds_read_b64_tr_b16 v[254:255], v7 offset:47392
  s_waitcnt vmcnt(0) lgkmcnt(0)
  v_mfma_f32_16x16x32_bf16 v[16:19], v[236:239], v[208:211], v[16:19]
  v_mfma_f32_16x16x32_bf16 v[20:23], v[236:239], v[212:215], v[20:23]
  v_mfma_f32_16x16x32_bf16 v[24:27], v[240:243], v[208:211], v[24:27]
  v_mfma_f32_16x16x32_bf16 v[28:31], v[240:243], v[212:215], v[28:31]
  v_mfma_f32_16x16x32_bf16 v[32:35], v[244:247], v[208:211], v[32:35]
  v_mfma_f32_16x16x32_bf16 v[36:39], v[244:247], v[212:215], v[36:39]
  v_mfma_f32_16x16x32_bf16 v[40:43], v[248:251], v[208:211], v[40:43]
  v_mfma_f32_16x16x32_bf16 v[44:47], v[248:251], v[212:215], v[44:47]
  v_mfma_f32_16x16x32_bf16 v[48:51], v[252:255], v[208:211], v[48:51]
  v_mfma_f32_16x16x32_bf16 v[52:55], v[252:255], v[212:215], v[52:55]
  s_nop 7
  v_cvt_pk_bf16_f32 v216, v16, v17
  v_cvt_pk_bf16_f32 v217, v18, v19
  ds_write_b64 v13, v[216:217] offset:0
  v_cvt_pk_bf16_f32 v218, v24, v25
  v_cvt_pk_bf16_f32 v219, v26, v27
  ds_write_b64 v13, v[218:219] offset:8
  v_cvt_pk_bf16_f32 v220, v32, v33
  v_cvt_pk_bf16_f32 v221, v34, v35
  ds_write_b64 v13, v[220:221] offset:16
  v_cvt_pk_bf16_f32 v222, v40, v41
  v_cvt_pk_bf16_f32 v223, v42, v43
  ds_write_b64 v13, v[222:223] offset:24
  v_cvt_pk_bf16_f32 v224, v48, v49
  v_cvt_pk_bf16_f32 v225, v50, v51
  ds_write_b64 v13, v[224:225] offset:32
  v_cvt_pk_bf16_f32 v226, v20, v21
  v_cvt_pk_bf16_f32 v227, v22, v23
  ds_write_b64 v13, v[226:227] offset:2560
  v_cvt_pk_bf16_f32 v228, v28, v29
  v_cvt_pk_bf16_f32 v229, v30, v31
  ds_write_b64 v13, v[228:229] offset:2568
  v_cvt_pk_bf16_f32 v230, v36, v37
  v_cvt_pk_bf16_f32 v231, v38, v39
  ds_write_b64 v13, v[230:231] offset:2576
  v_cvt_pk_bf16_f32 v232, v44, v45
  v_cvt_pk_bf16_f32 v233, v46, v47
  ds_write_b64 v13, v[232:233] offset:2584
  v_cvt_pk_bf16_f32 v234, v52, v53
  v_cvt_pk_bf16_f32 v235, v54, v55
  ds_write_b64 v13, v[234:235] offset:2592
  s_waitcnt lgkmcnt(0)
  ds_read_b128 v[56:59], v14 offset:0
  ds_read_b128 v[60:63], v14 offset:1024
  ds_read_b128 v[64:67], v14 offset:2048
  ds_read_b128 v[68:71], v14 offset:3072
  ds_read_b128 v[72:75], v14 offset:4096
  s_waitcnt lgkmcnt(4)
  buffer_store_dwordx4 v[56:59], v8, s[64:67], 0 offen
  s_waitcnt lgkmcnt(3)
  buffer_store_dwordx4 v[60:63], v9, s[64:67], 0 offen
  s_waitcnt lgkmcnt(2)
  buffer_store_dwordx4 v[64:67], v10, s[64:67], 0 offen
  s_waitcnt lgkmcnt(1)
  buffer_store_dwordx4 v[68:71], v11, s[64:67], 0 offen
  s_waitcnt lgkmcnt(0)
  buffer_store_dwordx4 v[72:75], v12, s[64:67], 0 offen
L_k2_done:
  s_endpgm
L_k2_bar2:
  s_barrier
  s_branch L_k2_barback2
L_k2_bar6:
  s_barrier
  s_branch L_k2_barback6
L_k2_hotend:
L_k2_slow0:
  v_mov_b32 v9, 0xff800000
  v_subrev_u32 v13, 163840, v7
  s_mov_b32 s24, 0
L_slow1_t0:
  buffer_load_dwordx4 v[40:43], v2, s[8:11], s24 offen
  buffer_load_dwordx2 v[48:49], v3, s[8:11], s24 offen
  s_waitcnt vmcnt(0)
  v_mfma_f32_32x32x16_bf16 v[132:147], v[40:43], v[16:19], 0
  v_mfma_f32_32x32x8bf16_1k v[132:147], v[48:49], v[32:33], v[132:147]
  s_nop 15
  v_max3_f32 v9, v132, v133, v9
  v_max3_f32 v9, v134, v135, v9
  v_max3_f32 v9, v136, v137, v9
  v_max3_f32 v9, v138, v139, v9
  v_max3_f32 v9, v140, v141, v9
  v_max3_f32 v9, v142, v143, v9
  v_max3_f32 v9, v144, v145, v9
  v_max3_f32 v9, v146, v147, v9
  s_add_u32 s24, s24, 2560
  s_cmp_lt_u32 s24, 163840
  s_cbranch_scc1 L_slow1_t0
  v_mov_b32 v10, v9
  s_nop 1
  v_permlane32_swap_b32 v9, v10
  s_nop 1
  v_max_f32 v9, v9, v10
  v_mov_b32 v68, 0
  v_mov_b32 v69, 0
  v_mov_b32 v70, 0
  v_mov_b32 v71, 0
  v_mov_b32 v72, 0
  v_mov_b32 v73, 0
  v_mov_b32 v74, 0
  v_mov_b32 v75, 0
  v_mov_b32 v76, 0
  v_mov_b32 v77, 0
  v_mov_b32 v78, 0
  v_mov_b32 v79, 0
  v_mov_b32 v80, 0
  v_mov_b32 v81, 0
  v_mov_b32 v82, 0
  v_mov_b32 v83, 0
  s_mov_b32 s24, 0
L_slow2_t0:
  buffer_load_dwordx4 v[40:43], v2, s[8:11], s24 offen
  buffer_load_dwordx2 v[48:49], v3, s[8:11], s24 offen
  s_mov_b64 exec, s[40:41]
  buffer_load_dwordx4 v[52:55], v13, s[8:11], s24 offen
  buffer_load_dwordx4 v[56:59], v13, s[8:11], s24 offen offset:640
  s_mov_b64 exec, -1
  s_waitcnt vmcnt(0)
  v_mfma_f32_32x32x16_bf16 v[132:147], v[40:43], v[16:19], 0
  v_mfma_f32_32x32x8bf16_1k v[132:147], v[48:49], v[32:33], v[132:147]
  s_nop 15
  v_sub_f32 v132, v132, v9
  v_sub_f32 v133, v133, v9
  v_sub_f32 v134, v134, v9
  v_sub_f32 v135, v135, v9
  v_sub_f32 v136, v136, v9
  v_sub_f32 v137, v137, v9
  v_sub_f32 v138, v138, v9
  v_sub_f32 v139, v139, v9
  v_sub_f32 v140, v140, v9
  v_sub_f32 v141, v141, v9
  v_sub_f32 v142, v142, v9
  v_sub_f32 v143, v143, v9
  v_sub_f32 v144, v144, v9
  v_sub_f32 v145, v145, v9
  v_sub_f32 v146, v146, v9
  v_sub_f32 v147, v147, v9
  v_exp_f32 v132, v132
  v_exp_f32 v133, v133
  v_exp_f32 v134, v134
  v_exp_f32 v135, v135
  v_exp_f32 v136, v136
  v_exp_f32 v137, v137
  v_exp_f32 v138, v138
  v_exp_f32 v139, v139
  v_exp_f32 v140, v140
  v_exp_f32 v141, v141
  v_exp_f32 v142, v142
  v_exp_f32 v143, v143
  v_exp_f32 v144, v144
  v_exp_f32 v145, v145
  v_exp_f32 v146, v146
  v_exp_f32 v147, v147
  s_nop 1
  v_smfmac_f32_32x32x32_bf16 v[68:83], v[52:55], v[132:139], v8
  v_smfmac_f32_32x32x32_bf16 v[68:83], v[56:59], v[140:147], v8
  s_add_u32 s24, s24, 2560
  s_cmp_lt_u32 s24, 163840
  s_cbranch_scc1 L_slow2_t0
  s_nop 15
  v_rcp_f32 v9, v78
  s_nop 0
  s_branch L_k2_ok0
L_k2_slow1:
  v_mov_b32 v9, 0xff800000
  v_subrev_u32 v13, 163840, v7
  s_mov_b32 s24, 0
L_slow1_t1:
  buffer_load_dwordx4 v[40:43], v2, s[8:11], s24 offen
  buffer_load_dwordx2 v[48:49], v3, s[8:11], s24 offen
  s_waitcnt vmcnt(0)
  v_mfma_f32_32x32x16_bf16 v[132:147], v[40:43], v[20:23], 0
  v_mfma_f32_32x32x8bf16_1k v[132:147], v[48:49], v[34:35], v[132:147]
  s_nop 15
  v_max3_f32 v9, v132, v133, v9
  v_max3_f32 v9, v134, v135, v9
  v_max3_f32 v9, v136, v137, v9
  v_max3_f32 v9, v138, v139, v9
  v_max3_f32 v9, v140, v141, v9
  v_max3_f32 v9, v142, v143, v9
  v_max3_f32 v9, v144, v145, v9
  v_max3_f32 v9, v146, v147, v9
  s_add_u32 s24, s24, 2560
  s_cmp_lt_u32 s24, 163840
  s_cbranch_scc1 L_slow1_t1
  v_mov_b32 v10, v9
  s_nop 1
  v_permlane32_swap_b32 v9, v10
  s_nop 1
  v_max_f32 v9, v9, v10
  v_mov_b32 v84, 0
  v_mov_b32 v85, 0
  v_mov_b32 v86, 0
  v_mov_b32 v87, 0
  v_mov_b32 v88, 0
  v_mov_b32 v89, 0
  v_mov_b32 v90, 0
  v_mov_b32 v91, 0
  v_mov_b32 v92, 0
  v_mov_b32 v93, 0
  v_mov_b32 v94, 0
  v_mov_b32 v95, 0
  v_mov_b32 v96, 0
  v_mov_b32 v97, 0
  v_mov_b32 v98, 0
  v_mov_b32 v99, 0
  s_mov_b32 s24, 0
L_slow2_t1:
  buffer_load_dwordx4 v[40:43], v2, s[8:11], s24 offen
  buffer_load_dwordx2 v[48:49], v3, s[8:11], s24 offen
  s_mov_b64 exec, s[40:41]
  buffer_load_dwordx4 v[52:55], v13, s[8:11], s24 offen
  buffer_load_dwordx4 v[56:59], v13, s[8:11], s24 offen offset:640
  s_mov_b64 exec, -1
  s_waitcnt vmcnt(0)
  v_mfma_f32_32x32x16_bf16 v[132:147], v[40:43], v[20:23], 0
  v_mfma_f32_32x32x8bf16_1k v[132:147], v[48:49], v[34:35], v[132:147]
  s_nop 15
  v_sub_f32 v132, v132, v9
  v_sub_f32 v133, v133, v9
  v_sub_f32 v134, v134, v9
  v_sub_f32 v135, v135, v9
  v_sub_f32 v136, v136, v9
  v_sub_f32 v137, v137, v9
  v_sub_f32 v138, v138, v9
  v_sub_f32 v139, v139, v9
  v_sub_f32 v140, v140, v9
  v_sub_f32 v141, v141, v9
  v_sub_f32 v142, v142, v9
  v_sub_f32 v143, v143, v9
  v_sub_f32 v144, v144, v9
  v_sub_f32 v145, v145, v9
  v_sub_f32 v146, v146, v9
  v_sub_f32 v147, v147, v9
  v_exp_f32 v132, v132
  v_exp_f32 v133, v133
  v_exp_f32 v134, v134
  v_exp_f32 v135, v135
  v_exp_f32 v136, v136
  v_exp_f32 v137, v137
  v_exp_f32 v138, v138
  v_exp_f32 v139, v139
  v_exp_f32 v140, v140
  v_exp_f32 v141, v141
  v_exp_f32 v142, v142
  v_exp_f32 v143, v143
  v_exp_f32 v144, v144
  v_exp_f32 v145, v145
  v_exp_f32 v146, v146
  v_exp_f32 v147, v147
  s_nop 1
  v_smfmac_f32_32x32x32_bf16 v[84:99], v[52:55], v[132:139], v8
  v_smfmac_f32_32x32x32_bf16 v[84:99], v[56:59], v[140:147], v8
  s_add_u32 s24, s24, 2560
  s_cmp_lt_u32 s24, 163840
  s_cbranch_scc1 L_slow2_t1
  s_nop 15
  v_rcp_f32 v9, v94
  s_nop 0
  s_branch L_k2_ok1
L_k2_slow2:
  v_mov_b32 v9, 0xff800000
  v_subrev_u32 v13, 163840, v7
  s_mov_b32 s24, 0
L_slow1_t2:
  buffer_load_dwordx4 v[40:43], v2, s[8:11], s24 offen
  buffer_load_dwordx2 v[48:49], v3, s[8:11], s24 offen
  s_waitcnt vmcnt(0)
  v_mfma_f32_32x32x16_bf16 v[132:147], v[40:43], v[24:27], 0
  v_mfma_f32_32x32x8bf16_1k v[132:147], v[48:49], v[36:37], v[132:147]
  s_nop 15
  v_max3_f32 v9, v132, v133, v9
  v_max3_f32 v9, v134, v135, v9
  v_max3_f32 v9, v136, v137, v9
  v_max3_f32 v9, v138, v139, v9
  v_max3_f32 v9, v140, v141, v9
  v_max3_f32 v9, v142, v143, v9
  v_max3_f32 v9, v144, v145, v9
  v_max3_f32 v9, v146, v147, v9
  s_add_u32 s24, s24, 2560
  s_cmp_lt_u32 s24, 163840
  s_cbranch_scc1 L_slow1_t2
  v_mov_b32 v10, v9
  s_nop 1
  v_permlane32_swap_b32 v9, v10
  s_nop 1
  v_max_f32 v9, v9, v10
  v_mov_b32 v100, 0
  v_mov_b32 v101, 0
  v_mov_b32 v102, 0
  v_mov_b32 v103, 0
  v_mov_b32 v104, 0
  v_mov_b32 v105, 0
  v_mov_b32 v106, 0
  v_mov_b32 v107, 0
  v_mov_b32 v108, 0
  v_mov_b32 v109, 0
  v_mov_b32 v110, 0
  v_mov_b32 v111, 0
  v_mov_b32 v112, 0
  v_mov_b32 v113, 0
  v_mov_b32 v114, 0
  v_mov_b32 v115, 0
  s_mov_b32 s24, 0
L_slow2_t2:
  buffer_load_dwordx4 v[40:43], v2, s[8:11], s24 offen
  buffer_load_dwordx2 v[48:49], v3, s[8:11], s24 offen
  s_mov_b64 exec, s[40:41]
  buffer_load_dwordx4 v[52:55], v13, s[8:11], s24 offen
  buffer_load_dwordx4 v[56:59], v13, s[8:11], s24 offen offset:640
  s_mov_b64 exec, -1
  s_waitcnt vmcnt(0)
  v_mfma_f32_32x32x16_bf16 v[132:147], v[40:43], v[24:27], 0
  v_mfma_f32_32x32x8bf16_1k v[132:147], v[48:49], v[36:37], v[132:147]
  s_nop 15
  v_sub_f32 v132, v132, v9
  v_sub_f32 v133, v133, v9
  v_sub_f32 v134, v134, v9
  v_sub_f32 v135, v135, v9
  v_sub_f32 v136, v136, v9
  v_sub_f32 v137, v137, v9
  v_sub_f32 v138, v138, v9
  v_sub_f32 v139, v139, v9
  v_sub_f32 v140, v140, v9
  v_sub_f32 v141, v141, v9
  v_sub_f32 v142, v142, v9
  v_sub_f32 v143, v143, v9
  v_sub_f32 v144, v144, v9
  v_sub_f32 v145, v145, v9
  v_sub_f32 v146, v146, v9
  v_sub_f32 v147, v147, v9
  v_exp_f32 v132, v132
  v_exp_f32 v133, v133
  v_exp_f32 v134, v134
  v_exp_f32 v135, v135
  v_exp_f32 v136, v136
  v_exp_f32 v137, v137
  v_exp_f32 v138, v138
  v_exp_f32 v139, v139
  v_exp_f32 v140, v140
  v_exp_f32 v141, v141
  v_exp_f32 v142, v142
  v_exp_f32 v143, v143
  v_exp_f32 v144, v144
  v_exp_f32 v145, v145
  v_exp_f32 v146, v146
  v_exp_f32 v147, v147
  s_nop 1
  v_smfmac_f32_32x32x32_bf16 v[100:115], v[52:55], v[132:139], v8
  v_smfmac_f32_32x32x32_bf16 v[100:115], v[56:59], v[140:147], v8
  s_add_u32 s24, s24, 2560
  s_cmp_lt_u32 s24, 163840
  s_cbranch_scc1 L_slow2_t2
  s_nop 15
  v_rcp_f32 v9, v110
  s_nop 0
  s_branch L_k2_ok2
L_k2_slow3:
  v_mov_b32 v9, 0xff800000
  v_subrev_u32 v13, 163840, v7
  s_mov_b32 s24, 0
L_slow1_t3:
  buffer_load_dwordx4 v[40:43], v2, s[8:11], s24 offen
  buffer_load_dwordx2 v[48:49], v3, s[8:11], s24 offen
  s_waitcnt vmcnt(0)
  v_mfma_f32_32x32x16_bf16 v[132:147], v[40:43], v[28:31], 0
  v_mfma_f32_32x32x8bf16_1k v[132:147], v[48:49], v[38:39], v[132:147]
  s_nop 15
  v_max3_f32 v9, v132, v133, v9
  v_max3_f32 v9, v134, v135, v9
  v_max3_f32 v9, v136, v137, v9
  v_max3_f32 v9, v138, v139, v9
  v_max3_f32 v9, v140, v141, v9
  v_max3_f32 v9, v142, v143, v9
  v_max3_f32 v9, v144, v145, v9
  v_max3_f32 v9, v146, v147, v9
  s_add_u32 s24, s24, 2560
  s_cmp_lt_u32 s24, 163840
  s_cbranch_scc1 L_slow1_t3
  v_mov_b32 v10, v9
  s_nop 1
  v_permlane32_swap_b32 v9, v10
  s_nop 1
  v_max_f32 v9, v9, v10
  v_mov_b32 v116, 0
  v_mov_b32 v117, 0
  v_mov_b32 v118, 0
  v_mov_b32 v119, 0
  v_mov_b32 v120, 0
  v_mov_b32 v121, 0
  v_mov_b32 v122, 0
  v_mov_b32 v123, 0
  v_mov_b32 v124, 0
  v_mov_b32 v125, 0
  v_mov_b32 v126, 0
  v_mov_b32 v127, 0
  v_mov_b32 v128, 0
  v_mov_b32 v129, 0
  v_mov_b32 v130, 0
  v_mov_b32 v131, 0
  s_mov_b32 s24, 0
L_slow2_t3:
  buffer_load_dwordx4 v[40:43], v2, s[8:11], s24 offen
  buffer_load_dwordx2 v[48:49], v3, s[8:11], s24 offen
  s_mov_b64 exec, s[40:41]
  buffer_load_dwordx4 v[52:55], v13, s[8:11], s24 offen
  buffer_load_dwordx4 v[56:59], v13, s[8:11], s24 offen offset:640
  s_mov_b64 exec, -1
  s_waitcnt vmcnt(0)
  v_mfma_f32_32x32x16_bf16 v[132:147], v[40:43], v[28:31], 0
  v_mfma_f32_32x32x8bf16_1k v[132:147], v[48:49], v[38:39], v[132:147]
  s_nop 15
  v_sub_f32 v132, v132, v9
  v_sub_f32 v133, v133, v9
  v_sub_f32 v134, v134, v9
  v_sub_f32 v135, v135, v9
  v_sub_f32 v136, v136, v9
  v_sub_f32 v137, v137, v9
  v_sub_f32 v138, v138, v9
  v_sub_f32 v139, v139, v9
  v_sub_f32 v140, v140, v9
  v_sub_f32 v141, v141, v9
  v_sub_f32 v142, v142, v9
  v_sub_f32 v143, v143, v9
  v_sub_f32 v144, v144, v9
  v_sub_f32 v145, v145, v9
  v_sub_f32 v146, v146, v9
  v_sub_f32 v147, v147, v9
  v_exp_f32 v132, v132
  v_exp_f32 v133, v133
  v_exp_f32 v134, v134
  v_exp_f32 v135, v135
  v_exp_f32 v136, v136
  v_exp_f32 v137, v137
  v_exp_f32 v138, v138
  v_exp_f32 v139, v139
  v_exp_f32 v140, v140
  v_exp_f32 v141, v141
  v_exp_f32 v142, v142
  v_exp_f32 v143, v143
  v_exp_f32 v144, v144
  v_exp_f32 v145, v145
  v_exp_f32 v146, v146
  v_exp_f32 v147, v147
  s_nop 1
  v_smfmac_f32_32x32x32_bf16 v[116:131], v[52:55], v[132:139], v8
  v_smfmac_f32_32x32x32_bf16 v[116:131], v[56:59], v[140:147], v8
  s_add_u32 s24, s24, 2560
  s_cmp_lt_u32 s24, 163840
  s_cbranch_scc1 L_slow2_t3
  s_nop 15
  v_rcp_f32 v9, v126
  s_nop 0
  s_branch L_k2_ok3
L_k2_end:
.section .rodata,"a"
.p2align 6
.amdhsa_kernel proj_kernel
  .amdhsa_next_free_vgpr 248
  .amdhsa_next_free_sgpr 96
  .amdhsa_accum_offset 248
  .amdhsa_group_segment_fixed_size 0
  .amdhsa_kernarg_size 88
  .amdhsa_user_sgpr_count 2
  .amdhsa_user_sgpr_kernarg_segment_ptr 1
  .amdhsa_system_sgpr_workgroup_id_x 1
.end_amdhsa_kernel

.p2align 6
.amdhsa_kernel attn_kernel
  .amdhsa_next_free_vgpr 256
  .amdhsa_next_free_sgpr 96
  .amdhsa_accum_offset 256
  .amdhsa_group_segment_fixed_size 0
  .amdhsa_kernarg_size 88
  .amdhsa_user_sgpr_count 2
  .amdhsa_user_sgpr_kernarg_segment_ptr 1
  .amdhsa_system_sgpr_workgroup_id_x 1
.end_amdhsa_kernel
```
